```python
import torch

def _softmax(x, axis=-1):
    return torch.softmax(x, dim=axis)
def _gelu(x):
    return torch.nn.functional.gelu(x, approximate="tanh")
def _silu(x):
    return torch.nn.functional.silu(x)
def _sigmoid(x):
    return torch.sigmoid(x)
def _layernorm(x, axis=-1, eps=1e-5):
    m = x.mean(dim=axis, keepdim=True)
    v = x.var(dim=axis, keepdim=True, unbiased=False)
    return (x - m) / torch.sqrt(v + eps)
def _scatter_add(tgt, idx, src, axis=0):
    return tgt.clone().index_add_(axis, idx, src)
def _segment_sum(src, seg, n):
    out = torch.zeros((n,) + src.shape[1:], dtype=src.dtype)
    return out.index_add_(0, seg, src)
def _pad(x, pw):
    flat = tuple(v for pair in reversed(pw) for v in pair)
    return torch.nn.functional.pad(x, flat)

kernel_name = 'gated_mix__softmax_full_mha__sliding_block__prompt'

def setup_inputs():

    _w = (lambda a: (lambda t: t.to(torch.bfloat16) if t.is_floating_point() else t)(torch.as_tensor(a)))
    def _A_setup():
        B, S, D = 1, 2048, 512
        return {
            "x": _w((lambda *s: torch.randn(*s, dtype=torch.bfloat16) * 0.05)(B, S, D)),
            "wqkv": _w((lambda *s: torch.randn(*s, dtype=torch.bfloat16) * 1.6)(D, 3 * D)),
            "wo": _w((lambda *s: torch.randn(*s, dtype=torch.bfloat16) * 0.1)(D, D)),
        }
    _A_in = _A_setup()

    def _B_setup():
        B, S, D = 1, 2048, 512
        return {
            "x": _w((lambda *s: torch.randn(*s, dtype=torch.bfloat16) * 0.05)(B, S, D)),
            "wqkv": _w((lambda *s: torch.randn(*s, dtype=torch.bfloat16) * 1.6)(D, 3 * D)),
            "wo": _w((lambda *s: torch.randn(*s, dtype=torch.bfloat16) * 0.05)(D, D)),
        }
    _B_in = _B_setup()

    return {
        "A_x": _A_in["x"],
        "A_wqkv": _A_in["wqkv"],
        "A_wo": _A_in["wo"],
        "B_x": _B_in["x"],
        "B_wqkv": _B_in["wqkv"],
        "B_wo": _B_in["wo"],
        "gate_w": _w((lambda *s: torch.randn(*s, dtype=torch.bfloat16) * 0.05)(512) * 16.0),
    }

def reference(A_x, A_wqkv, A_wo, B_x, B_wqkv, B_wo, gate_w):
    def _A_ref(x, wqkv, wo):
        B, S, D = x.shape
        H = 32; Dh = D // H
        qkv = (lambda x, *d: x.permute(*d))((x @ wqkv).reshape(B, S, 3, H, Dh), 2, 0, 3, 1, 4)
        q, k, v = qkv[0], qkv[1], qkv[2]
        scale = Dh ** -0.5
        scores = torch.einsum("bhqd,bhkd->bhqk", q, k) * scale
        p = _softmax(scores, axis=-1)
        o = torch.einsum("bhqk,bhkd->bhqd", p, v)
        return (lambda x, *d: x.permute(*d))(o, 0, 2, 1, 3).reshape(B, S, D) @ wo

    def _B_ref(x, wqkv, wo):
        B, S, D = x.shape
        H = 32; Dh = D // H; W = 256
        qkv = (lambda x, *d: x.permute(*d))((x @ wqkv).reshape(B, S, 3, H, Dh), 2, 0, 3, 1, 4)
        q, k, v = qkv[0], qkv[1], qkv[2]
        scores = torch.einsum("bhqd,bhkd->bhqk", q, k) * (Dh ** -0.5)
        idx = torch.arange(S)
        mask = (idx[:, None] - idx[None, :] >= 0) & (idx[:, None] - idx[None, :] < W)
        scores = torch.where(mask[None, None], scores, -1e9)
        p = _softmax(scores, axis=-1)
        o = torch.einsum("bhqk,bhkd->bhqd", p, v)
        return (lambda x, *d: x.permute(*d))(o, 0, 2, 1, 3).reshape(B, S, D) @ wo

    x = A_x
    g = _sigmoid((x * gate_w).sum(-1, keepdims=True))
    a = _A_ref(x, A_wqkv, A_wo)
    b = _B_ref(x, B_wqkv, B_wo)
    return g * a + (1 - g) * b
```

```asm
; @launch grid=(256,1,1) block=(512,1,1) lds=163840
.amdgcn_target "amdgcn-amd-amdhsa--gfx950"
.text
.globl gated_mix__softmax_full_mha__sliding_block__prompt_kernel
.p2align 8
.type gated_mix__softmax_full_mha__sliding_block__prompt_kernel,@function
gated_mix__softmax_full_mha__sliding_block__prompt_kernel:
    s_cmp_ge_u32 s2, 256
    s_cbranch_scc1 gated_mix__softmax_full_mha__sliding_block__prompt_kernel_end
    s_load_dwordx4 s[4:7], s[0:1], 0
    s_load_dwordx2 s[10:11], s[0:1], 72
    s_load_dwordx4 s[12:15], s[0:1], 32
    s_load_dwordx4 s[16:19], s[0:1], 48
    s_load_dwordx2 s[8:9], s[0:1], 16
    v_lshrrev_b32 v2, 6, v0
    v_and_b32 v1, 63, v0
    v_readfirstlane_b32 s40, v2
    s_and_b32 s45, s2, 7
    s_lshr_b32 s46, s2, 3
    s_and_b32 s47, s45, 1
    s_lshl_b32 s47, s47, 3
    s_and_b32 s48, s46, 7
    s_add_u32 s42, s47, s48
    s_lshr_b32 s47, s45, 1
    s_lshl_b32 s47, s47, 2
    s_lshr_b32 s48, s46, 3
    s_add_u32 s41, s47, s48
    s_lshr_b32 s44, s40, 2
    s_lshl_b32 s43, s41, 1
    s_add_u32 s43, s43, s44
    s_and_b32 s45, s41, 1
    s_lshl_b32 s45, s45, 2
    s_add_u32 s45, s45, s42
    s_and_b32 s67, s45, 7
    s_waitcnt lgkmcnt(0)
    s_mov_b32 s20, s4
    s_and_b32 s21, s5, 0xffff
    s_mov_b32 s22, 2097152
    s_mov_b32 s23, 0x20000
    s_mov_b32 s24, s6
    s_and_b32 s25, s7, 0xffff
    s_mov_b32 s26, 1572864
    s_mov_b32 s27, 0x20000
    s_mov_b32 s32, s12
    s_and_b32 s33, s13, 0xffff
    s_mov_b32 s34, 1572864
    s_mov_b32 s35, 0x20000
    s_cmp_ge_u32 s40, 4
    s_cbranch_scc1 gated_mix__softmax_full_mha__sliding_block__prompt_kernel_loader
    s_mov_b32 s28, s10
    s_and_b32 s29, s11, 0xffff
    s_mov_b32 s30, 19922944
    s_mov_b32 s31, 0x20000
    v_mov_b32 v174, 0
    v_lshlrev_b32 v157, 4, v1
    v_lshlrev_b32 v175, 7, v1
    s_mov_b32 s45, 18087936
    buffer_load_dwordx2 v[172:173], v174, s[28:31], s45 offen sc1
    s_cmp_lg_u32 s40, 0
    s_cbranch_scc1 gated_mix__softmax_full_mha__sliding_block__prompt_kernel_noones
    v_mov_b32 v160, 0x3f803f80
    v_mov_b32 v161, 0x3f803f80
    v_mov_b32 v162, 0x3f803f80
    v_mov_b32 v163, 0x3f803f80
    v_and_b32 v4, 11, v1
    v_cmp_eq_u32 vcc, 0, v4
    s_nop 1
    v_cndmask_b32 v160, 0, v160, vcc
    v_cndmask_b32 v161, 0, v161, vcc
    v_cndmask_b32 v162, 0, v162, vcc
    v_cndmask_b32 v163, 0, v163, vcc
    s_lshl_b32 s45, s2, 10
    s_add_u32 s45, s45, 18350080
    buffer_store_dwordx4 v[160:163], v157, s[28:31], s45 offen
gated_mix__softmax_full_mha__sliding_block__prompt_kernel_noones:
    v_and_b32 v2, 31, v1
    v_lshrrev_b32 v3, 5, v1
    s_lshl_b32 s45, s40, 5
    v_add_u32 v4, s45, v2
    v_bfe_u32 v5, v4, 1, 3
    v_xor_b32 v5, v5, v3
    v_lshlrev_b32 v5, 4, v5
    v_lshl_add_u32 v8, v4, 7, v5
    v_xor_b32 v9, 32, v8
    v_xor_b32 v10, 64, v8
    v_xor_b32 v11, 0x60, v8
    v_add_u32 v12, 65536, v8
    v_add_u32 v13, 65536, v9
    v_add_u32 v14, 65536, v10
    v_add_u32 v15, 65536, v11
    v_bfe_u32 v4, v1, 2, 2
    v_and_b32 v5, 3, v1
    v_lshl_add_u32 v6, v3, 3, v4
    v_bfe_u32 v7, v1, 4, 1
    v_lshlrev_b32 v18, 6, v6
    v_lshl_add_u32 v18, v7, 5, v18
    v_lshl_add_u32 v18, v5, 3, v18
    v_add_u32 v18, 81920, v18
    v_lshlrev_b32 v7, 1, v7
    v_lshrrev_b32 v20, 1, v5
    v_add_u32 v7, v7, v20
    v_bfe_u32 v20, v4, 1, 1
    v_lshlrev_b32 v20, 2, v20
    v_xor_b32 v7, v7, v20
    v_lshlrev_b32 v7, 4, v7
    v_and_b32 v5, 1, v5
    v_lshl_add_u32 v7, v5, 3, v7
    v_lshl_add_u32 v7, v6, 7, v7
    v_add_u32 v16, 90112, v7
    v_xor_b32 v17, 64, v16
    v_lshlrev_b32 v19, 4, v3
    s_lshl_b32 s45, s67, 7
    s_add_u32 s45, s45, 161792
    v_add_u32 v19, s45, v19
    s_and_b32 s51, s40, 3
    v_lshrrev_b32 v3, 5, v1
    v_and_b32 v4, 15, v1
    v_lshlrev_b32 v4, 4, v4
    v_lshl_add_u32 v5, v3, 8, v4
    v_add_u32 v5, 1024, v5
    s_lshl_b32 s45, s2, 10
    s_add_u32 s45, s45, 18350080
    v_add_u32 v4, s45, v4
    v_bfe_u32 v6, v1, 4, 1
    v_xor_b32 v153, 1, v6
    v_mul_u32_u24 v5, v5, v153
    v_sub_u32 v6, 0, v6
    v_and_b32 v4, v4, v6
    v_add_u32 v156, v4, v5
    s_lshl_b32 s45, s43, 6
    s_lshl_b32 s46, s51, 4
    s_add_u32 s45, s45, s46
    s_lshl_b32 s45, s45, 11
    s_add_u32 s68, s45, 4194304
    s_add_u32 s69, s68, 32768
    s_and_b32 s45, s42, 7
    s_lshl_b32 s45, s45, 12
    s_add_u32 s52, s68, s45
    s_mov_b32 s4, s8
    s_and_b32 s5, s9, 0xffff
    s_mov_b32 s6, 524288
    s_mov_b32 s7, 0x20000
    s_mov_b32 s12, s14
    s_and_b32 s13, s15, 0xffff
    s_mov_b32 s14, 524288
    s_mov_b32 s15, 0x20000
    v_lshrrev_b32 v6, 3, v1
    v_bfe_u32 v7, v1, 4, 1
    v_lshlrev_b32 v7, 2, v7
    v_and_b32 v154, 7, v1
    v_xor_b32 v154, v154, v7
    v_lshlrev_b32 v154, 4, v154
    v_lshl_add_u32 v154, v6, 10, v154
    s_lshr_b32 s45, s2, 5
    s_lshl_b32 s45, s45, 7
    v_add_u32 v154, s45, v154
    v_lshrrev_b32 v3, 5, v1
    s_lshr_b32 s45, s41, 1
    s_lshl_b32 s45, s45, 8
    s_lshl_b32 s46, s42, 2
    s_add_u32 s45, s45, s46
    s_add_u32 s45, s45, s40
    s_lshl_b32 s45, s45, 11
    s_add_u32 s45, s45, 4194304
    s_and_b32 s46, s41, 1
    s_cmp_lg_u32 s46, 0
    s_cbranch_scc1 gated_mix__softmax_full_mha__sliding_block__prompt_kernel_vtype
    v_mov_b32 v167, v157
    s_add_u32 s70, s45, 0
    s_add_u32 s71, s45, 131072
    s_add_u32 s64, s45, 262144
    s_add_u32 s65, s45, 393216
    s_barrier
    ds_read_b128 v[24:27], v8 offset:0
    ds_read_b64_tr_b16 v[28:29], v16 offset:0
    ds_read_b64_tr_b16 v[30:31], v16 offset:512
    ds_read_b64_tr_b16 v[32:33], v17 offset:0
    ds_read_b64_tr_b16 v[34:35], v17 offset:512
    ds_read_b128 v[44:47], v19 offset:0
    ds_read_b128 v[48:51], v9 offset:0
    ds_read_b64_tr_b16 v[52:53], v16 offset:2048
    ds_read_b64_tr_b16 v[54:55], v16 offset:2560
    ds_read_b64_tr_b16 v[56:57], v17 offset:2048
    ds_read_b64_tr_b16 v[58:59], v17 offset:2560
    ds_read_b128 v[68:71], v19 offset:32
    s_waitcnt lgkmcnt(6)
    v_mfma_f32_32x32x16_bf16 v[120:135], v[28:31], v[24:27], 0
    ds_read_b128 v[72:75], v10 offset:0
    ds_read_b64_tr_b16 v[76:77], v16 offset:4096
    v_mfma_f32_32x32x16_bf16 v[136:151], v[32:35], v[24:27], 0
    ds_read_b64_tr_b16 v[78:79], v16 offset:4608
    ds_read_b64_tr_b16 v[80:81], v17 offset:4096
    v_mfma_f32_32x32x16_bf16 v[240:255], v[44:47], v[24:27], 0
    ds_read_b64_tr_b16 v[82:83], v17 offset:4608
    ds_read_b128 v[92:95], v19 offset:64
    s_waitcnt lgkmcnt(6)
    v_mfma_f32_32x32x16_bf16 v[120:135], v[52:55], v[48:51], v[120:135]
    ds_read_b128 v[96:99], v11 offset:0
    ds_read_b64_tr_b16 v[100:101], v16 offset:6144
    v_mfma_f32_32x32x16_bf16 v[136:151], v[56:59], v[48:51], v[136:151]
    ds_read_b64_tr_b16 v[102:103], v16 offset:6656
    ds_read_b64_tr_b16 v[104:105], v17 offset:6144
    v_mfma_f32_32x32x16_bf16 v[240:255], v[68:71], v[48:51], v[240:255]
    ds_read_b64_tr_b16 v[106:107], v17 offset:6656
    ds_read_b128 v[116:119], v19 offset:96
    s_waitcnt lgkmcnt(0)
    s_barrier
    v_mfma_f32_32x32x16_bf16 v[120:135], v[76:79], v[72:75], v[120:135]
    ds_read_b128 v[24:27], v8 offset:16384
    ds_read_b64_tr_b16 v[28:29], v16 offset:16384
    v_mfma_f32_32x32x16_bf16 v[136:151], v[80:83], v[72:75], v[136:151]
    ds_read_b64_tr_b16 v[30:31], v16 offset:16896
    ds_read_b64_tr_b16 v[32:33], v17 offset:16384
    v_mfma_f32_32x32x16_bf16 v[240:255], v[92:95], v[72:75], v[240:255]
    ds_read_b64_tr_b16 v[34:35], v17 offset:16896
    ds_read_b128 v[44:47], v19 offset:128
    v_mfma_f32_32x32x16_bf16 v[120:135], v[100:103], v[96:99], v[120:135]
    ds_read_b128 v[48:51], v9 offset:16384
    ds_read_b64_tr_b16 v[52:53], v16 offset:18432
    v_mfma_f32_32x32x16_bf16 v[136:151], v[104:107], v[96:99], v[136:151]
    ds_read_b64_tr_b16 v[54:55], v16 offset:18944
    ds_read_b64_tr_b16 v[56:57], v17 offset:18432
    v_mfma_f32_32x32x16_bf16 v[240:255], v[116:119], v[96:99], v[240:255]
    ds_read_b64_tr_b16 v[58:59], v17 offset:18944
    ds_read_b128 v[68:71], v19 offset:160
    s_waitcnt lgkmcnt(6)
    v_mfma_f32_32x32x16_bf16 v[120:135], v[28:31], v[24:27], v[120:135]
    ds_read_b128 v[72:75], v10 offset:16384
    ds_read_b64_tr_b16 v[76:77], v16 offset:20480
    v_mfma_f32_32x32x16_bf16 v[136:151], v[32:35], v[24:27], v[136:151]
    ds_read_b64_tr_b16 v[78:79], v16 offset:20992
    ds_read_b64_tr_b16 v[80:81], v17 offset:20480
    v_mfma_f32_32x32x16_bf16 v[240:255], v[44:47], v[24:27], v[240:255]
    ds_read_b64_tr_b16 v[82:83], v17 offset:20992
    ds_read_b128 v[92:95], v19 offset:192
    s_waitcnt lgkmcnt(6)
    v_mfma_f32_32x32x16_bf16 v[120:135], v[52:55], v[48:51], v[120:135]
    ds_read_b128 v[96:99], v11 offset:16384
    ds_read_b64_tr_b16 v[100:101], v16 offset:22528
    v_mfma_f32_32x32x16_bf16 v[136:151], v[56:59], v[48:51], v[136:151]
    ds_read_b64_tr_b16 v[102:103], v16 offset:23040
    ds_read_b64_tr_b16 v[104:105], v17 offset:22528
    v_mfma_f32_32x32x16_bf16 v[240:255], v[68:71], v[48:51], v[240:255]
    ds_read_b64_tr_b16 v[106:107], v17 offset:23040
    ds_read_b128 v[116:119], v19 offset:224
    s_waitcnt lgkmcnt(0)
    s_barrier
    v_mfma_f32_32x32x16_bf16 v[120:135], v[76:79], v[72:75], v[120:135]
    ds_read_b128 v[24:27], v8 offset:32768
    ds_read_b64_tr_b16 v[28:29], v16 offset:32768
    v_mfma_f32_32x32x16_bf16 v[136:151], v[80:83], v[72:75], v[136:151]
    ds_read_b64_tr_b16 v[30:31], v16 offset:33280
    ds_read_b64_tr_b16 v[32:33], v17 offset:32768
    v_mfma_f32_32x32x16_bf16 v[240:255], v[92:95], v[72:75], v[240:255]
    ds_read_b64_tr_b16 v[34:35], v17 offset:33280
    ds_read_b128 v[44:47], v19 offset:256
    s_cmp_lg_u32 s40, 1
    s_cbranch_scc1 gated_mix__softmax_full_mha__sliding_block__prompt_kernel_k_wpf_1
    s_and_b32 s45, s41, 1
    s_lshl_b32 s45, s45, 3
    s_and_b32 s46, s42, 7
    s_add_u32 s45, s45, s46
    s_and_b32 s46, s45, 3
    s_lshl_b32 s46, s46, 7
    v_add_u32 v4, s46, v1
    v_mul_u32_u24 v4, 3072, v4
    v_add_u32 v5, 196608, v4
    s_lshr_b32 s45, s45, 2
    s_lshr_b32 s46, s41, 1
    s_lshl_b32 s46, s46, 7
    s_cmp_eq_u32 s45, 0
    s_cbranch_scc0 gated_mix__softmax_full_mha__sliding_block__prompt_kernel_k_wpf_1_b
    buffer_load_dword v163, v4, s[24:27], s46 offen
    buffer_load_dword v162, v5, s[24:27], s46 offen
    s_branch gated_mix__softmax_full_mha__sliding_block__prompt_kernel_k_wpf_1
gated_mix__softmax_full_mha__sliding_block__prompt_kernel_k_wpf_1_b:
    s_sub_u32 s45, s45, 1
    s_lshl_b32 s45, s45, 10
    s_add_u32 s46, s46, s45
    buffer_load_dword v163, v4, s[32:35], s46 offen
    buffer_load_dword v162, v5, s[32:35], s46 offen
gated_mix__softmax_full_mha__sliding_block__prompt_kernel_k_wpf_1:
    v_mfma_f32_32x32x16_bf16 v[120:135], v[100:103], v[96:99], v[120:135]
    ds_read_b128 v[48:51], v9 offset:32768
    ds_read_b64_tr_b16 v[52:53], v16 offset:34816
    v_mfma_f32_32x32x16_bf16 v[136:151], v[104:107], v[96:99], v[136:151]
    ds_read_b64_tr_b16 v[54:55], v16 offset:35328
    ds_read_b64_tr_b16 v[56:57], v17 offset:34816
    v_mfma_f32_32x32x16_bf16 v[240:255], v[116:119], v[96:99], v[240:255]
    ds_read_b64_tr_b16 v[58:59], v17 offset:35328
    ds_read_b128 v[68:71], v19 offset:288
    s_waitcnt lgkmcnt(6)
    v_mfma_f32_32x32x16_bf16 v[120:135], v[28:31], v[24:27], v[120:135]
    ds_read_b128 v[72:75], v10 offset:32768
    ds_read_b64_tr_b16 v[76:77], v16 offset:36864
    v_mfma_f32_32x32x16_bf16 v[136:151], v[32:35], v[24:27], v[136:151]
    ds_read_b64_tr_b16 v[78:79], v16 offset:37376
    ds_read_b64_tr_b16 v[80:81], v17 offset:36864
    v_mfma_f32_32x32x16_bf16 v[240:255], v[44:47], v[24:27], v[240:255]
    ds_read_b64_tr_b16 v[82:83], v17 offset:37376
    ds_read_b128 v[92:95], v19 offset:320
    s_waitcnt lgkmcnt(6)
    v_mfma_f32_32x32x16_bf16 v[120:135], v[52:55], v[48:51], v[120:135]
    ds_read_b128 v[96:99], v11 offset:32768
    ds_read_b64_tr_b16 v[100:101], v16 offset:38912
    v_mfma_f32_32x32x16_bf16 v[136:151], v[56:59], v[48:51], v[136:151]
    ds_read_b64_tr_b16 v[102:103], v16 offset:39424
    ds_read_b64_tr_b16 v[104:105], v17 offset:38912
    v_mfma_f32_32x32x16_bf16 v[240:255], v[68:71], v[48:51], v[240:255]
    ds_read_b64_tr_b16 v[106:107], v17 offset:39424
    ds_read_b128 v[116:119], v19 offset:352
    s_waitcnt lgkmcnt(0)
    s_barrier
    v_mfma_f32_32x32x16_bf16 v[120:135], v[76:79], v[72:75], v[120:135]
    ds_read_b128 v[24:27], v8 offset:49152
    ds_read_b64_tr_b16 v[28:29], v16 offset:49152
    v_mfma_f32_32x32x16_bf16 v[136:151], v[80:83], v[72:75], v[136:151]
    ds_read_b64_tr_b16 v[30:31], v16 offset:49664
    ds_read_b64_tr_b16 v[32:33], v17 offset:49152
    v_mfma_f32_32x32x16_bf16 v[240:255], v[92:95], v[72:75], v[240:255]
    ds_read_b64_tr_b16 v[34:35], v17 offset:49664
    ds_read_b128 v[44:47], v19 offset:384
    v_mfma_f32_32x32x16_bf16 v[120:135], v[100:103], v[96:99], v[120:135]
    ds_read_b128 v[48:51], v9 offset:49152
    ds_read_b64_tr_b16 v[52:53], v16 offset:51200
    v_mfma_f32_32x32x16_bf16 v[136:151], v[104:107], v[96:99], v[136:151]
    ds_read_b64_tr_b16 v[54:55], v16 offset:51712
    ds_read_b64_tr_b16 v[56:57], v17 offset:51200
    v_mfma_f32_32x32x16_bf16 v[240:255], v[116:119], v[96:99], v[240:255]
    ds_read_b64_tr_b16 v[58:59], v17 offset:51712
    ds_read_b128 v[68:71], v19 offset:416
    s_waitcnt lgkmcnt(6)
    v_mfma_f32_32x32x16_bf16 v[120:135], v[28:31], v[24:27], v[120:135]
    ds_read_b128 v[72:75], v10 offset:49152
    ds_read_b64_tr_b16 v[76:77], v16 offset:53248
    v_mfma_f32_32x32x16_bf16 v[136:151], v[32:35], v[24:27], v[136:151]
    ds_read_b64_tr_b16 v[78:79], v16 offset:53760
    ds_read_b64_tr_b16 v[80:81], v17 offset:53248
    v_mfma_f32_32x32x16_bf16 v[240:255], v[44:47], v[24:27], v[240:255]
    ds_read_b64_tr_b16 v[82:83], v17 offset:53760
    ds_read_b128 v[92:95], v19 offset:448
    s_waitcnt lgkmcnt(6)
    v_mfma_f32_32x32x16_bf16 v[120:135], v[52:55], v[48:51], v[120:135]
    ds_read_b128 v[96:99], v11 offset:49152
    ds_read_b64_tr_b16 v[100:101], v16 offset:55296
    v_mfma_f32_32x32x16_bf16 v[136:151], v[56:59], v[48:51], v[136:151]
    ds_read_b64_tr_b16 v[102:103], v16 offset:55808
    ds_read_b64_tr_b16 v[104:105], v17 offset:55296
    v_mfma_f32_32x32x16_bf16 v[240:255], v[68:71], v[48:51], v[240:255]
    ds_read_b64_tr_b16 v[106:107], v17 offset:55808
    ds_read_b128 v[116:119], v19 offset:480
    s_waitcnt lgkmcnt(0)
    s_barrier
    v_mfma_f32_32x32x16_bf16 v[120:135], v[76:79], v[72:75], v[120:135]
    ds_read_b128 v[24:27], v12 offset:0
    ds_read_b64_tr_b16 v[28:29], v16 offset:0
    v_mfma_f32_32x32x16_bf16 v[136:151], v[80:83], v[72:75], v[136:151]
    ds_read_b64_tr_b16 v[30:31], v16 offset:512
    ds_read_b64_tr_b16 v[32:33], v17 offset:0
    v_mfma_f32_32x32x16_bf16 v[240:255], v[92:95], v[72:75], v[240:255]
    ds_read_b64_tr_b16 v[34:35], v17 offset:512
    ds_read_b128 v[44:47], v19 offset:512
    v_mfma_f32_32x32x16_bf16 v[120:135], v[100:103], v[96:99], v[120:135]
    ds_read_b128 v[48:51], v13 offset:0
    ds_read_b64_tr_b16 v[52:53], v16 offset:2048
    v_mfma_f32_32x32x16_bf16 v[136:151], v[104:107], v[96:99], v[136:151]
    ds_read_b64_tr_b16 v[54:55], v16 offset:2560
    ds_read_b64_tr_b16 v[56:57], v17 offset:2048
    v_mfma_f32_32x32x16_bf16 v[240:255], v[116:119], v[96:99], v[240:255]
    ds_read_b64_tr_b16 v[58:59], v17 offset:2560
    ds_read_b128 v[68:71], v19 offset:544
    s_waitcnt lgkmcnt(6)
    v_mfma_f32_32x32x16_bf16 v[120:135], v[28:31], v[24:27], v[120:135]
    ds_read_b128 v[72:75], v14 offset:0
    ds_read_b64_tr_b16 v[76:77], v16 offset:4096
    v_mfma_f32_32x32x16_bf16 v[136:151], v[32:35], v[24:27], v[136:151]
    ds_read_b64_tr_b16 v[78:79], v16 offset:4608
    ds_read_b64_tr_b16 v[80:81], v17 offset:4096
    v_mfma_f32_32x32x16_bf16 v[240:255], v[44:47], v[24:27], v[240:255]
    ds_read_b64_tr_b16 v[82:83], v17 offset:4608
    ds_read_b128 v[92:95], v19 offset:576
    s_waitcnt lgkmcnt(6)
    v_mfma_f32_32x32x16_bf16 v[120:135], v[52:55], v[48:51], v[120:135]
    ds_read_b128 v[96:99], v15 offset:0
    ds_read_b64_tr_b16 v[100:101], v16 offset:6144
    v_mfma_f32_32x32x16_bf16 v[136:151], v[56:59], v[48:51], v[136:151]
    ds_read_b64_tr_b16 v[102:103], v16 offset:6656
    ds_read_b64_tr_b16 v[104:105], v17 offset:6144
    v_mfma_f32_32x32x16_bf16 v[240:255], v[68:71], v[48:51], v[240:255]
    ds_read_b64_tr_b16 v[106:107], v17 offset:6656
    ds_read_b128 v[116:119], v19 offset:608
    s_waitcnt lgkmcnt(0)
    s_barrier
    v_mfma_f32_32x32x16_bf16 v[120:135], v[76:79], v[72:75], v[120:135]
    ds_read_b128 v[24:27], v8 offset:0
    ds_read_b64_tr_b16 v[28:29], v16 offset:16384
    v_mfma_f32_32x32x16_bf16 v[136:151], v[80:83], v[72:75], v[136:151]
    ds_read_b64_tr_b16 v[30:31], v16 offset:16896
    ds_read_b64_tr_b16 v[32:33], v17 offset:16384
    v_mfma_f32_32x32x16_bf16 v[240:255], v[92:95], v[72:75], v[240:255]
    ds_read_b64_tr_b16 v[34:35], v17 offset:16896
    ds_read_b128 v[44:47], v19 offset:640
    v_mfma_f32_32x32x16_bf16 v[120:135], v[100:103], v[96:99], v[120:135]
    ds_read_b128 v[48:51], v9 offset:0
    ds_read_b64_tr_b16 v[52:53], v16 offset:18432
    v_mfma_f32_32x32x16_bf16 v[136:151], v[104:107], v[96:99], v[136:151]
    ds_read_b64_tr_b16 v[54:55], v16 offset:18944
    ds_read_b64_tr_b16 v[56:57], v17 offset:18432
    v_mfma_f32_32x32x16_bf16 v[240:255], v[116:119], v[96:99], v[240:255]
    ds_read_b64_tr_b16 v[58:59], v17 offset:18944
    ds_read_b128 v[68:71], v19 offset:672
    s_waitcnt lgkmcnt(6)
    v_mfma_f32_32x32x16_bf16 v[120:135], v[28:31], v[24:27], v[120:135]
    ds_read_b128 v[72:75], v10 offset:0
    ds_read_b64_tr_b16 v[76:77], v16 offset:20480
    v_mfma_f32_32x32x16_bf16 v[136:151], v[32:35], v[24:27], v[136:151]
    ds_read_b64_tr_b16 v[78:79], v16 offset:20992
    ds_read_b64_tr_b16 v[80:81], v17 offset:20480
    v_mfma_f32_32x32x16_bf16 v[240:255], v[44:47], v[24:27], v[240:255]
    ds_read_b64_tr_b16 v[82:83], v17 offset:20992
    ds_read_b128 v[92:95], v19 offset:704
    s_waitcnt vmcnt(0)
    v_add_co_u32 v172, vcc, 1, v172
    s_nop 1
    v_addc_co_u32 v173, vcc, 0, v173, vcc
    s_lshl_b32 s62, s41, 4
    s_add_u32 s62, s62, s42
    s_lshl_b32 s62, s62, 2
    s_add_u32 s62, s62, s40
    s_lshl_b32 s62, s62, 7
    s_add_u32 s62, s62, 18874368
    s_mov_b32 s63, 0
    s_waitcnt lgkmcnt(6)
    v_mfma_f32_32x32x16_bf16 v[120:135], v[52:55], v[48:51], v[120:135]
    ds_read_b128 v[96:99], v11 offset:0
    ds_read_b64_tr_b16 v[100:101], v16 offset:22528
    v_mfma_f32_32x32x16_bf16 v[136:151], v[56:59], v[48:51], v[136:151]
    ds_read_b64_tr_b16 v[102:103], v16 offset:23040
    ds_read_b64_tr_b16 v[104:105], v17 offset:22528
    v_mfma_f32_32x32x16_bf16 v[240:255], v[68:71], v[48:51], v[240:255]
    ds_read_b64_tr_b16 v[106:107], v17 offset:23040
    ds_read_b128 v[116:119], v19 offset:736
    s_waitcnt lgkmcnt(0)
    s_barrier
    v_mfma_f32_32x32x16_bf16 v[120:135], v[76:79], v[72:75], v[120:135]
    ds_read_b128 v[24:27], v8 offset:16384
    ds_read_b64_tr_b16 v[28:29], v16 offset:32768
    v_mfma_f32_32x32x16_bf16 v[136:151], v[80:83], v[72:75], v[136:151]
    ds_read_b64_tr_b16 v[30:31], v16 offset:33280
    ds_read_b64_tr_b16 v[32:33], v17 offset:32768
    v_mfma_f32_32x32x16_bf16 v[240:255], v[92:95], v[72:75], v[240:255]
    ds_read_b64_tr_b16 v[34:35], v17 offset:33280
    ds_read_b128 v[44:47], v19 offset:768
    v_mfma_f32_32x32x16_bf16 v[120:135], v[100:103], v[96:99], v[120:135]
    ds_read_b128 v[48:51], v9 offset:16384
    ds_read_b64_tr_b16 v[52:53], v16 offset:34816
    v_mfma_f32_32x32x16_bf16 v[136:151], v[104:107], v[96:99], v[136:151]
    ds_read_b64_tr_b16 v[54:55], v16 offset:35328
    ds_read_b64_tr_b16 v[56:57], v17 offset:34816
    v_mfma_f32_32x32x16_bf16 v[240:255], v[116:119], v[96:99], v[240:255]
    ds_read_b64_tr_b16 v[58:59], v17 offset:35328
    ds_read_b128 v[68:71], v19 offset:800
    s_waitcnt lgkmcnt(6)
    v_mfma_f32_32x32x16_bf16 v[120:135], v[28:31], v[24:27], v[120:135]
    ds_read_b128 v[72:75], v10 offset:16384
    ds_read_b64_tr_b16 v[76:77], v16 offset:36864
    v_mfma_f32_32x32x16_bf16 v[136:151], v[32:35], v[24:27], v[136:151]
    ds_read_b64_tr_b16 v[78:79], v16 offset:37376
    ds_read_b64_tr_b16 v[80:81], v17 offset:36864
    v_mfma_f32_32x32x16_bf16 v[240:255], v[44:47], v[24:27], v[240:255]
    ds_read_b64_tr_b16 v[82:83], v17 offset:37376
    ds_read_b128 v[92:95], v19 offset:832
    s_waitcnt lgkmcnt(6)
    v_mfma_f32_32x32x16_bf16 v[120:135], v[52:55], v[48:51], v[120:135]
    ds_read_b128 v[96:99], v11 offset:16384
    ds_read_b64_tr_b16 v[100:101], v16 offset:38912
    v_mfma_f32_32x32x16_bf16 v[136:151], v[56:59], v[48:51], v[136:151]
    ds_read_b64_tr_b16 v[102:103], v16 offset:39424
    ds_read_b64_tr_b16 v[104:105], v17 offset:38912
    v_mfma_f32_32x32x16_bf16 v[240:255], v[68:71], v[48:51], v[240:255]
    ds_read_b64_tr_b16 v[106:107], v17 offset:39424
    ds_read_b128 v[116:119], v19 offset:864
    s_waitcnt lgkmcnt(0)
    s_barrier
    v_mfma_f32_32x32x16_bf16 v[120:135], v[76:79], v[72:75], v[120:135]
    ds_read_b128 v[24:27], v8 offset:32768
    ds_read_b64_tr_b16 v[28:29], v16 offset:49152
    v_mfma_f32_32x32x16_bf16 v[136:151], v[80:83], v[72:75], v[136:151]
    ds_read_b64_tr_b16 v[30:31], v16 offset:49664
    ds_read_b64_tr_b16 v[32:33], v17 offset:49152
    v_mfma_f32_32x32x16_bf16 v[240:255], v[92:95], v[72:75], v[240:255]
    ds_read_b64_tr_b16 v[34:35], v17 offset:49664
    ds_read_b128 v[44:47], v19 offset:896
    v_mfma_f32_32x32x16_bf16 v[120:135], v[100:103], v[96:99], v[120:135]
    ds_read_b128 v[48:51], v9 offset:32768
    ds_read_b64_tr_b16 v[52:53], v16 offset:51200
    v_mfma_f32_32x32x16_bf16 v[136:151], v[104:107], v[96:99], v[136:151]
    ds_read_b64_tr_b16 v[54:55], v16 offset:51712
    ds_read_b64_tr_b16 v[56:57], v17 offset:51200
    v_mfma_f32_32x32x16_bf16 v[240:255], v[116:119], v[96:99], v[240:255]
    ds_read_b64_tr_b16 v[58:59], v17 offset:51712
    ds_read_b128 v[68:71], v19 offset:928
    s_waitcnt lgkmcnt(6)
    v_mfma_f32_32x32x16_bf16 v[120:135], v[28:31], v[24:27], v[120:135]
    ds_read_b128 v[72:75], v10 offset:32768
    ds_read_b64_tr_b16 v[76:77], v16 offset:53248
    v_mfma_f32_32x32x16_bf16 v[136:151], v[32:35], v[24:27], v[136:151]
    ds_read_b64_tr_b16 v[78:79], v16 offset:53760
    ds_read_b64_tr_b16 v[80:81], v17 offset:53248
    v_mfma_f32_32x32x16_bf16 v[240:255], v[44:47], v[24:27], v[240:255]
    ds_read_b64_tr_b16 v[82:83], v17 offset:53760
    ds_read_b128 v[92:95], v19 offset:960
    s_waitcnt lgkmcnt(6)
    v_mfma_f32_32x32x16_bf16 v[120:135], v[52:55], v[48:51], v[120:135]
    ds_read_b128 v[96:99], v11 offset:32768
    ds_read_b64_tr_b16 v[100:101], v16 offset:55296
    v_mfma_f32_32x32x16_bf16 v[136:151], v[56:59], v[48:51], v[136:151]
    ds_read_b64_tr_b16 v[102:103], v16 offset:55808
    ds_read_b64_tr_b16 v[104:105], v17 offset:55296
    v_mfma_f32_32x32x16_bf16 v[240:255], v[68:71], v[48:51], v[240:255]
    ds_read_b64_tr_b16 v[106:107], v17 offset:55808
    ds_read_b128 v[116:119], v19 offset:992
    s_waitcnt lgkmcnt(0)
    s_barrier
    v_mfma_f32_32x32x16_bf16 v[120:135], v[76:79], v[72:75], v[120:135]
    ds_read_b128 v[24:27], v8 offset:49152
    ds_read_b64_tr_b16 v[36:37], v16 offset:0
    ds_read_b64_tr_b16 v[38:39], v16 offset:512
    v_mfma_f32_32x32x16_bf16 v[136:151], v[80:83], v[72:75], v[136:151]
    ds_read_b64_tr_b16 v[40:41], v17 offset:0
    ds_read_b64_tr_b16 v[42:43], v17 offset:512
    ds_read_b64_tr_b16 v[28:29], v18 offset:0
    v_mfma_f32_32x32x16_bf16 v[240:255], v[92:95], v[72:75], v[240:255]
    ds_read_b64_tr_b16 v[30:31], v18 offset:256
    ds_read_b64_tr_b16 v[32:33], v18 offset:4096
    ds_read_b64_tr_b16 v[34:35], v18 offset:4352
    v_mfma_f32_32x32x16_bf16 v[120:135], v[100:103], v[96:99], v[120:135]
    ds_read_b128 v[48:51], v9 offset:49152
    ds_read_b64_tr_b16 v[60:61], v16 offset:2048
    ds_read_b64_tr_b16 v[62:63], v16 offset:2560
    v_mfma_f32_32x32x16_bf16 v[136:151], v[104:107], v[96:99], v[136:151]
    ds_read_b64_tr_b16 v[64:65], v17 offset:2048
    ds_read_b64_tr_b16 v[66:67], v17 offset:2560
    s_waitcnt lgkmcnt(5)
    ds_read_b64_tr_b16 v[52:53], v18 offset:1024
    v_mfma_f32_32x32x16_bf16 v[240:255], v[116:119], v[96:99], v[240:255]
    ds_read_b64_tr_b16 v[54:55], v18 offset:1280
    ds_read_b64_tr_b16 v[56:57], v18 offset:5120
    ds_read_b64_tr_b16 v[58:59], v18 offset:5376
    v_mfma_f32_32x32x16_bf16 v[208:223], v[36:39], v[24:27], 0
    ds_read_b128 v[72:75], v10 offset:49152
    ds_read_b64_tr_b16 v[84:85], v16 offset:4096
    ds_read_b64_tr_b16 v[86:87], v16 offset:4608
    v_mfma_f32_32x32x16_bf16 v[224:239], v[40:43], v[24:27], 0
    ds_read_b64_tr_b16 v[88:89], v17 offset:4096
    ds_read_b64_tr_b16 v[90:91], v17 offset:4608
    s_waitcnt lgkmcnt(5)
    ds_read_b64_tr_b16 v[76:77], v18 offset:2048
    v_mfma_f32_32x32x16_bf16 v[176:191], v[28:31], v[24:27], 0
    ds_read_b64_tr_b16 v[78:79], v18 offset:2304
    ds_read_b64_tr_b16 v[80:81], v18 offset:6144
    ds_read_b64_tr_b16 v[82:83], v18 offset:6400
    v_mfma_f32_32x32x16_bf16 v[192:207], v[32:35], v[24:27], 0
    v_cvt_pk_bf16_f32 v120, v120, v121
    v_cvt_pk_bf16_f32 v121, v122, v123
    v_cvt_pk_bf16_f32 v122, v124, v125
    v_cvt_pk_bf16_f32 v123, v126, v127
    v_cvt_pk_bf16_f32 v124, v128, v129
    v_cvt_pk_bf16_f32 v125, v130, v131
    v_cvt_pk_bf16_f32 v126, v132, v133
    v_cvt_pk_bf16_f32 v127, v134, v135
    buffer_store_dwordx4 v[120:123], v167, s[28:31], s70 offen sc1
    buffer_store_dwordx4 v[124:127], v167, s[28:31], s71 offen sc1
    v_mfma_f32_32x32x16_bf16 v[208:223], v[60:63], v[48:51], v[208:223]
    ds_read_b128 v[96:99], v11 offset:49152
    ds_read_b64_tr_b16 v[108:109], v16 offset:6144
    ds_read_b64_tr_b16 v[110:111], v16 offset:6656
    v_mfma_f32_32x32x16_bf16 v[224:239], v[64:67], v[48:51], v[224:239]
    ds_read_b64_tr_b16 v[112:113], v17 offset:6144
    ds_read_b64_tr_b16 v[114:115], v17 offset:6656
    s_waitcnt lgkmcnt(5)
    ds_read_b64_tr_b16 v[100:101], v18 offset:3072
    v_mfma_f32_32x32x16_bf16 v[176:191], v[52:55], v[48:51], v[176:191]
    ds_read_b64_tr_b16 v[102:103], v18 offset:3328
    ds_read_b64_tr_b16 v[104:105], v18 offset:7168
    ds_read_b64_tr_b16 v[106:107], v18 offset:7424
    v_mfma_f32_32x32x16_bf16 v[192:207], v[56:59], v[48:51], v[192:207]
    v_cvt_pk_bf16_f32 v136, v136, v137
    v_cvt_pk_bf16_f32 v137, v138, v139
    v_cvt_pk_bf16_f32 v138, v140, v141
    v_cvt_pk_bf16_f32 v139, v142, v143
    v_cvt_pk_bf16_f32 v140, v144, v145
    v_cvt_pk_bf16_f32 v141, v146, v147
    v_cvt_pk_bf16_f32 v142, v148, v149
    v_cvt_pk_bf16_f32 v143, v150, v151
    buffer_store_dwordx4 v[136:139], v167, s[28:31], s64 offen sc1
    buffer_store_dwordx4 v[140:143], v167, s[28:31], s65 offen sc1
    s_waitcnt lgkmcnt(0)
    s_barrier
    v_mfma_f32_32x32x16_bf16 v[208:223], v[84:87], v[72:75], v[208:223]
    ds_read_b128 v[24:27], v12 offset:0
    ds_read_b64_tr_b16 v[36:37], v16 offset:16384
    ds_read_b64_tr_b16 v[38:39], v16 offset:16896
    v_mfma_f32_32x32x16_bf16 v[224:239], v[88:91], v[72:75], v[224:239]
    ds_read_b64_tr_b16 v[40:41], v17 offset:16384
    ds_read_b64_tr_b16 v[42:43], v17 offset:16896
    ds_read_b64_tr_b16 v[28:29], v18 offset:16384
    v_mfma_f32_32x32x16_bf16 v[176:191], v[76:79], v[72:75], v[176:191]
    ds_read_b64_tr_b16 v[30:31], v18 offset:16640
    ds_read_b64_tr_b16 v[32:33], v18 offset:20480
    ds_read_b64_tr_b16 v[34:35], v18 offset:20736
    v_mfma_f32_32x32x16_bf16 v[192:207], v[80:83], v[72:75], v[192:207]
    v_cvt_pk_bf16_f32 v241, v240, v240
    v_lshlrev_b32 v241, 16, v241
    v_mul_f32 v241, 0xbfb8aa3b, v241
    v_exp_f32 v241, v241
    s_nop 0
    v_add_f32 v241, 1.0, v241
    v_rcp_f32 v241, v241
    s_nop 0
    v_cvt_pk_bf16_f32 v241, v241, v241
    v_lshlrev_b32 v241, 16, v241
    v_mfma_f32_32x32x16_bf16 v[208:223], v[108:111], v[96:99], v[208:223]
    ds_read_b128 v[48:51], v13 offset:0
    ds_read_b64_tr_b16 v[60:61], v16 offset:18432
    ds_read_b64_tr_b16 v[62:63], v16 offset:18944
    v_mfma_f32_32x32x16_bf16 v[224:239], v[112:115], v[96:99], v[224:239]
    ds_read_b64_tr_b16 v[64:65], v17 offset:18432
    ds_read_b64_tr_b16 v[66:67], v17 offset:18944
    s_waitcnt lgkmcnt(5)
    ds_read_b64_tr_b16 v[52:53], v18 offset:17408
    v_mfma_f32_32x32x16_bf16 v[176:191], v[100:103], v[96:99], v[176:191]
    ds_read_b64_tr_b16 v[54:55], v18 offset:17664
    ds_read_b64_tr_b16 v[56:57], v18 offset:21504
    ds_read_b64_tr_b16 v[58:59], v18 offset:21760
    v_mfma_f32_32x32x16_bf16 v[192:207], v[104:107], v[96:99], v[192:207]
    v_mfma_f32_32x32x16_bf16 v[208:223], v[36:39], v[24:27], v[208:223]
    ds_read_b128 v[72:75], v14 offset:0
    ds_read_b64_tr_b16 v[84:85], v16 offset:20480
    ds_read_b64_tr_b16 v[86:87], v16 offset:20992
    v_mfma_f32_32x32x16_bf16 v[224:239], v[40:43], v[24:27], v[224:239]
    ds_read_b64_tr_b16 v[88:89], v17 offset:20480
    ds_read_b64_tr_b16 v[90:91], v17 offset:20992
    s_waitcnt lgkmcnt(5)
    ds_read_b64_tr_b16 v[76:77], v18 offset:18432
    v_mfma_f32_32x32x16_bf16 v[176:191], v[28:31], v[24:27], v[176:191]
    ds_read_b64_tr_b16 v[78:79], v18 offset:18688
    ds_read_b64_tr_b16 v[80:81], v18 offset:22528
    ds_read_b64_tr_b16 v[82:83], v18 offset:22784
    v_mfma_f32_32x32x16_bf16 v[192:207], v[32:35], v[24:27], v[192:207]
    v_mfma_f32_32x32x16_bf16 v[208:223], v[60:63], v[48:51], v[208:223]
    ds_read_b128 v[96:99], v15 offset:0
    ds_read_b64_tr_b16 v[108:109], v16 offset:22528
    ds_read_b64_tr_b16 v[110:111], v16 offset:23040
    v_mfma_f32_32x32x16_bf16 v[224:239], v[64:67], v[48:51], v[224:239]
    ds_read_b64_tr_b16 v[112:113], v17 offset:22528
    ds_read_b64_tr_b16 v[114:115], v17 offset:23040
    s_waitcnt lgkmcnt(5)
    ds_read_b64_tr_b16 v[100:101], v18 offset:19456
    v_mfma_f32_32x32x16_bf16 v[176:191], v[52:55], v[48:51], v[176:191]
    ds_read_b64_tr_b16 v[102:103], v18 offset:19712
    ds_read_b64_tr_b16 v[104:105], v18 offset:23552
    ds_read_b64_tr_b16 v[106:107], v18 offset:23808
    v_mfma_f32_32x32x16_bf16 v[192:207], v[56:59], v[48:51], v[192:207]
    s_waitcnt lgkmcnt(0)
    s_barrier
    v_mfma_f32_32x32x16_bf16 v[208:223], v[84:87], v[72:75], v[208:223]
    ds_read_b128 v[24:27], v8 offset:0
    ds_read_b64_tr_b16 v[36:37], v16 offset:32768
    ds_read_b64_tr_b16 v[38:39], v16 offset:33280
    v_mfma_f32_32x32x16_bf16 v[224:239], v[88:91], v[72:75], v[224:239]
    ds_read_b64_tr_b16 v[40:41], v17 offset:32768
    ds_read_b64_tr_b16 v[42:43], v17 offset:33280
    ds_read_b64_tr_b16 v[28:29], v18 offset:32768
    v_mfma_f32_32x32x16_bf16 v[176:191], v[76:79], v[72:75], v[176:191]
    ds_read_b64_tr_b16 v[30:31], v18 offset:33024
    ds_read_b64_tr_b16 v[32:33], v18 offset:36864
    ds_read_b64_tr_b16 v[34:35], v18 offset:37120
    v_mfma_f32_32x32x16_bf16 v[192:207], v[80:83], v[72:75], v[192:207]
    v_mfma_f32_32x32x16_bf16 v[208:223], v[108:111], v[96:99], v[208:223]
    ds_read_b128 v[48:51], v9 offset:0
    ds_read_b64_tr_b16 v[60:61], v16 offset:34816
    ds_read_b64_tr_b16 v[62:63], v16 offset:35328
    v_mfma_f32_32x32x16_bf16 v[224:239], v[112:115], v[96:99], v[224:239]
    ds_read_b64_tr_b16 v[64:65], v17 offset:34816
    ds_read_b64_tr_b16 v[66:67], v17 offset:35328
    s_waitcnt lgkmcnt(5)
    ds_read_b64_tr_b16 v[52:53], v18 offset:33792
    v_mfma_f32_32x32x16_bf16 v[176:191], v[100:103], v[96:99], v[176:191]
    ds_read_b64_tr_b16 v[54:55], v18 offset:34048
    ds_read_b64_tr_b16 v[56:57], v18 offset:37888
    ds_read_b64_tr_b16 v[58:59], v18 offset:38144
    v_mfma_f32_32x32x16_bf16 v[192:207], v[104:107], v[96:99], v[192:207]
    v_mfma_f32_32x32x16_bf16 v[208:223], v[36:39], v[24:27], v[208:223]
    ds_read_b128 v[72:75], v10 offset:0
    ds_read_b64_tr_b16 v[84:85], v16 offset:36864
    ds_read_b64_tr_b16 v[86:87], v16 offset:37376
    v_mfma_f32_32x32x16_bf16 v[224:239], v[40:43], v[24:27], v[224:239]
    ds_read_b64_tr_b16 v[88:89], v17 offset:36864
    ds_read_b64_tr_b16 v[90:91], v17 offset:37376
    s_waitcnt lgkmcnt(5)
    ds_read_b64_tr_b16 v[76:77], v18 offset:34816
    v_mfma_f32_32x32x16_bf16 v[176:191], v[28:31], v[24:27], v[176:191]
    ds_read_b64_tr_b16 v[78:79], v18 offset:35072
    ds_read_b64_tr_b16 v[80:81], v18 offset:38912
    ds_read_b64_tr_b16 v[82:83], v18 offset:39168
    v_mfma_f32_32x32x16_bf16 v[192:207], v[32:35], v[24:27], v[192:207]
    s_cmp_lg_u32 s63, 0
    s_cbranch_scc1 gated_mix__softmax_full_mha__sliding_block__prompt_kernel_k_fa_2
    s_getreg_b32 s45, hwreg(HW_REG_IB_STS)
    s_and_b32 s45, s45, 0x00c0000f
    s_cbranch_scc1 gated_mix__softmax_full_mha__sliding_block__prompt_kernel_k_fa_2
    s_mov_b64 exec, 1
    buffer_store_dwordx2 v[172:173], v174, s[28:31], s62 offen sc1
    s_mov_b64 exec, -1
    s_mov_b32 s63, 1
gated_mix__softmax_full_mha__sliding_block__prompt_kernel_k_fa_2:
    v_mfma_f32_32x32x16_bf16 v[208:223], v[60:63], v[48:51], v[208:223]
    ds_read_b128 v[96:99], v11 offset:0
    ds_read_b64_tr_b16 v[108:109], v16 offset:38912
    ds_read_b64_tr_b16 v[110:111], v16 offset:39424
    v_mfma_f32_32x32x16_bf16 v[224:239], v[64:67], v[48:51], v[224:239]
    ds_read_b64_tr_b16 v[112:113], v17 offset:38912
    ds_read_b64_tr_b16 v[114:115], v17 offset:39424
    s_waitcnt lgkmcnt(5)
    ds_read_b64_tr_b16 v[100:101], v18 offset:35840
    v_mfma_f32_32x32x16_bf16 v[176:191], v[52:55], v[48:51], v[176:191]
    ds_read_b64_tr_b16 v[102:103], v18 offset:36096
    ds_read_b64_tr_b16 v[104:105], v18 offset:39936
    ds_read_b64_tr_b16 v[106:107], v18 offset:40192
    v_mfma_f32_32x32x16_bf16 v[192:207], v[56:59], v[48:51], v[192:207]
    s_waitcnt lgkmcnt(0)
    s_barrier
    v_mfma_f32_32x32x16_bf16 v[208:223], v[84:87], v[72:75], v[208:223]
    ds_read_b128 v[24:27], v8 offset:16384
    ds_read_b64_tr_b16 v[36:37], v16 offset:49152
    ds_read_b64_tr_b16 v[38:39], v16 offset:49664
    v_mfma_f32_32x32x16_bf16 v[224:239], v[88:91], v[72:75], v[224:239]
    ds_read_b64_tr_b16 v[40:41], v17 offset:49152
    ds_read_b64_tr_b16 v[42:43], v17 offset:49664
    ds_read_b64_tr_b16 v[28:29], v18 offset:49152
    v_mfma_f32_32x32x16_bf16 v[176:191], v[76:79], v[72:75], v[176:191]
    ds_read_b64_tr_b16 v[30:31], v18 offset:49408
    ds_read_b64_tr_b16 v[32:33], v18 offset:53248
    ds_read_b64_tr_b16 v[34:35], v18 offset:53504
    v_mfma_f32_32x32x16_bf16 v[192:207], v[80:83], v[72:75], v[192:207]
    s_cmp_lg_u32 s63, 0
    s_cbranch_scc1 gated_mix__softmax_full_mha__sliding_block__prompt_kernel_k_fa_3
    s_getreg_b32 s45, hwreg(HW_REG_IB_STS)
    s_and_b32 s45, s45, 0x00c0000f
    s_cbranch_scc1 gated_mix__softmax_full_mha__sliding_block__prompt_kernel_k_fa_3
    s_mov_b64 exec, 1
    buffer_store_dwordx2 v[172:173], v174, s[28:31], s62 offen sc1
    s_mov_b64 exec, -1
    s_mov_b32 s63, 1
gated_mix__softmax_full_mha__sliding_block__prompt_kernel_k_fa_3:
    v_mfma_f32_32x32x16_bf16 v[208:223], v[108:111], v[96:99], v[208:223]
    ds_read_b128 v[48:51], v9 offset:16384
    ds_read_b64_tr_b16 v[60:61], v16 offset:51200
    ds_read_b64_tr_b16 v[62:63], v16 offset:51712
    v_mfma_f32_32x32x16_bf16 v[224:239], v[112:115], v[96:99], v[224:239]
    ds_read_b64_tr_b16 v[64:65], v17 offset:51200
    ds_read_b64_tr_b16 v[66:67], v17 offset:51712
    s_waitcnt lgkmcnt(5)
    ds_read_b64_tr_b16 v[52:53], v18 offset:50176
    v_mfma_f32_32x32x16_bf16 v[176:191], v[100:103], v[96:99], v[176:191]
    ds_read_b64_tr_b16 v[54:55], v18 offset:50432
    ds_read_b64_tr_b16 v[56:57], v18 offset:54272
    ds_read_b64_tr_b16 v[58:59], v18 offset:54528
    v_mfma_f32_32x32x16_bf16 v[192:207], v[104:107], v[96:99], v[192:207]
    v_mfma_f32_32x32x16_bf16 v[208:223], v[36:39], v[24:27], v[208:223]
    ds_read_b128 v[72:75], v10 offset:16384
    ds_read_b64_tr_b16 v[84:85], v16 offset:53248
    ds_read_b64_tr_b16 v[86:87], v16 offset:53760
    v_mfma_f32_32x32x16_bf16 v[224:239], v[40:43], v[24:27], v[224:239]
    ds_read_b64_tr_b16 v[88:89], v17 offset:53248
    ds_read_b64_tr_b16 v[90:91], v17 offset:53760
    s_waitcnt lgkmcnt(5)
    ds_read_b64_tr_b16 v[76:77], v18 offset:51200
    v_mfma_f32_32x32x16_bf16 v[176:191], v[28:31], v[24:27], v[176:191]
    ds_read_b64_tr_b16 v[78:79], v18 offset:51456
    ds_read_b64_tr_b16 v[80:81], v18 offset:55296
    ds_read_b64_tr_b16 v[82:83], v18 offset:55552
    v_mfma_f32_32x32x16_bf16 v[192:207], v[32:35], v[24:27], v[192:207]
    s_cmp_lg_u32 s63, 0
    s_cbranch_scc1 gated_mix__softmax_full_mha__sliding_block__prompt_kernel_k_fa_4
    s_getreg_b32 s45, hwreg(HW_REG_IB_STS)
    s_and_b32 s45, s45, 0x00c0000f
    s_cbranch_scc1 gated_mix__softmax_full_mha__sliding_block__prompt_kernel_k_fa_4
    s_mov_b64 exec, 1
    buffer_store_dwordx2 v[172:173], v174, s[28:31], s62 offen sc1
    s_mov_b64 exec, -1
    s_mov_b32 s63, 1
gated_mix__softmax_full_mha__sliding_block__prompt_kernel_k_fa_4:
    v_mfma_f32_32x32x16_bf16 v[208:223], v[60:63], v[48:51], v[208:223]
    ds_read_b128 v[96:99], v11 offset:16384
    ds_read_b64_tr_b16 v[108:109], v16 offset:55296
    ds_read_b64_tr_b16 v[110:111], v16 offset:55808
    v_mfma_f32_32x32x16_bf16 v[224:239], v[64:67], v[48:51], v[224:239]
    ds_read_b64_tr_b16 v[112:113], v17 offset:55296
    ds_read_b64_tr_b16 v[114:115], v17 offset:55808
    s_waitcnt lgkmcnt(5)
    ds_read_b64_tr_b16 v[100:101], v18 offset:52224
    v_mfma_f32_32x32x16_bf16 v[176:191], v[52:55], v[48:51], v[176:191]
    ds_read_b64_tr_b16 v[102:103], v18 offset:52480
    ds_read_b64_tr_b16 v[104:105], v18 offset:56320
    ds_read_b64_tr_b16 v[106:107], v18 offset:56576
    v_mfma_f32_32x32x16_bf16 v[192:207], v[56:59], v[48:51], v[192:207]
    s_waitcnt lgkmcnt(0)
    s_barrier
    v_mfma_f32_32x32x16_bf16 v[208:223], v[84:87], v[72:75], v[208:223]
    ds_read_b128 v[24:27], v8 offset:32768
    ds_read_b64_tr_b16 v[36:37], v16 offset:0
    ds_read_b64_tr_b16 v[38:39], v16 offset:512
    v_mfma_f32_32x32x16_bf16 v[224:239], v[88:91], v[72:75], v[224:239]
    ds_read_b64_tr_b16 v[40:41], v17 offset:0
    ds_read_b64_tr_b16 v[42:43], v17 offset:512
    ds_read_b64_tr_b16 v[28:29], v18 offset:0
    v_mfma_f32_32x32x16_bf16 v[176:191], v[76:79], v[72:75], v[176:191]
    ds_read_b64_tr_b16 v[30:31], v18 offset:256
    ds_read_b64_tr_b16 v[32:33], v18 offset:4096
    ds_read_b64_tr_b16 v[34:35], v18 offset:4352
    v_mfma_f32_32x32x16_bf16 v[192:207], v[80:83], v[72:75], v[192:207]
    s_cmp_lg_u32 s63, 0
    s_cbranch_scc1 gated_mix__softmax_full_mha__sliding_block__prompt_kernel_k_fa_5
    s_getreg_b32 s45, hwreg(HW_REG_IB_STS)
    s_and_b32 s45, s45, 0x00c0000f
    s_cbranch_scc1 gated_mix__softmax_full_mha__sliding_block__prompt_kernel_k_fa_5
    s_mov_b64 exec, 1
    buffer_store_dwordx2 v[172:173], v174, s[28:31], s62 offen sc1
    s_mov_b64 exec, -1
    s_mov_b32 s63, 1
gated_mix__softmax_full_mha__sliding_block__prompt_kernel_k_fa_5:
    v_mfma_f32_32x32x16_bf16 v[208:223], v[108:111], v[96:99], v[208:223]
    ds_read_b128 v[48:51], v9 offset:32768
    ds_read_b64_tr_b16 v[60:61], v16 offset:2048
    ds_read_b64_tr_b16 v[62:63], v16 offset:2560
    v_mfma_f32_32x32x16_bf16 v[224:239], v[112:115], v[96:99], v[224:239]
    ds_read_b64_tr_b16 v[64:65], v17 offset:2048
    ds_read_b64_tr_b16 v[66:67], v17 offset:2560
    s_waitcnt lgkmcnt(5)
    ds_read_b64_tr_b16 v[52:53], v18 offset:1024
    v_mfma_f32_32x32x16_bf16 v[176:191], v[100:103], v[96:99], v[176:191]
    ds_read_b64_tr_b16 v[54:55], v18 offset:1280
    ds_read_b64_tr_b16 v[56:57], v18 offset:5120
    ds_read_b64_tr_b16 v[58:59], v18 offset:5376
    v_mfma_f32_32x32x16_bf16 v[192:207], v[104:107], v[96:99], v[192:207]
    v_mfma_f32_32x32x16_bf16 v[208:223], v[36:39], v[24:27], v[208:223]
    ds_read_b128 v[72:75], v10 offset:32768
    ds_read_b64_tr_b16 v[84:85], v16 offset:4096
    ds_read_b64_tr_b16 v[86:87], v16 offset:4608
    v_mfma_f32_32x32x16_bf16 v[224:239], v[40:43], v[24:27], v[224:239]
    ds_read_b64_tr_b16 v[88:89], v17 offset:4096
    ds_read_b64_tr_b16 v[90:91], v17 offset:4608
    s_waitcnt lgkmcnt(5)
    ds_read_b64_tr_b16 v[76:77], v18 offset:2048
    v_mfma_f32_32x32x16_bf16 v[176:191], v[28:31], v[24:27], v[176:191]
    ds_read_b64_tr_b16 v[78:79], v18 offset:2304
    ds_read_b64_tr_b16 v[80:81], v18 offset:6144
    ds_read_b64_tr_b16 v[82:83], v18 offset:6400
    v_mfma_f32_32x32x16_bf16 v[192:207], v[32:35], v[24:27], v[192:207]
    s_cmp_lg_u32 s63, 0
    s_cbranch_scc1 gated_mix__softmax_full_mha__sliding_block__prompt_kernel_k_fa_6
    s_getreg_b32 s45, hwreg(HW_REG_IB_STS)
    s_and_b32 s45, s45, 0x00c0000f
    s_cbranch_scc1 gated_mix__softmax_full_mha__sliding_block__prompt_kernel_k_fa_6
    s_mov_b64 exec, 1
    buffer_store_dwordx2 v[172:173], v174, s[28:31], s62 offen sc1
    s_mov_b64 exec, -1
    s_mov_b32 s63, 1
gated_mix__softmax_full_mha__sliding_block__prompt_kernel_k_fa_6:
    v_mfma_f32_32x32x16_bf16 v[208:223], v[60:63], v[48:51], v[208:223]
    ds_read_b128 v[96:99], v11 offset:32768
    ds_read_b64_tr_b16 v[108:109], v16 offset:6144
    ds_read_b64_tr_b16 v[110:111], v16 offset:6656
    v_mfma_f32_32x32x16_bf16 v[224:239], v[64:67], v[48:51], v[224:239]
    ds_read_b64_tr_b16 v[112:113], v17 offset:6144
    ds_read_b64_tr_b16 v[114:115], v17 offset:6656
    s_waitcnt lgkmcnt(5)
    ds_read_b64_tr_b16 v[100:101], v18 offset:3072
    v_mfma_f32_32x32x16_bf16 v[176:191], v[52:55], v[48:51], v[176:191]
    ds_read_b64_tr_b16 v[102:103], v18 offset:3328
    ds_read_b64_tr_b16 v[104:105], v18 offset:7168
    ds_read_b64_tr_b16 v[106:107], v18 offset:7424
    v_mfma_f32_32x32x16_bf16 v[192:207], v[56:59], v[48:51], v[192:207]
    s_waitcnt lgkmcnt(0)
    s_barrier
    v_mfma_f32_32x32x16_bf16 v[208:223], v[84:87], v[72:75], v[208:223]
    ds_read_b128 v[24:27], v8 offset:49152
    ds_read_b64_tr_b16 v[36:37], v16 offset:16384
    ds_read_b64_tr_b16 v[38:39], v16 offset:16896
    v_mfma_f32_32x32x16_bf16 v[224:239], v[88:91], v[72:75], v[224:239]
    ds_read_b64_tr_b16 v[40:41], v17 offset:16384
    ds_read_b64_tr_b16 v[42:43], v17 offset:16896
    ds_read_b64_tr_b16 v[28:29], v18 offset:16384
    v_mfma_f32_32x32x16_bf16 v[176:191], v[76:79], v[72:75], v[176:191]
    ds_read_b64_tr_b16 v[30:31], v18 offset:16640
    ds_read_b64_tr_b16 v[32:33], v18 offset:20480
    ds_read_b64_tr_b16 v[34:35], v18 offset:20736
    v_mfma_f32_32x32x16_bf16 v[192:207], v[80:83], v[72:75], v[192:207]
    s_cmp_lg_u32 s63, 0
    s_cbranch_scc1 gated_mix__softmax_full_mha__sliding_block__prompt_kernel_k_fa_7
    s_getreg_b32 s45, hwreg(HW_REG_IB_STS)
    s_and_b32 s45, s45, 0x00c0000f
    s_cbranch_scc1 gated_mix__softmax_full_mha__sliding_block__prompt_kernel_k_fa_7
    s_mov_b64 exec, 1
    buffer_store_dwordx2 v[172:173], v174, s[28:31], s62 offen sc1
    s_mov_b64 exec, -1
    s_mov_b32 s63, 1
gated_mix__softmax_full_mha__sliding_block__prompt_kernel_k_fa_7:
    v_mfma_f32_32x32x16_bf16 v[208:223], v[108:111], v[96:99], v[208:223]
    ds_read_b128 v[48:51], v9 offset:49152
    ds_read_b64_tr_b16 v[60:61], v16 offset:18432
    ds_read_b64_tr_b16 v[62:63], v16 offset:18944
    v_mfma_f32_32x32x16_bf16 v[224:239], v[112:115], v[96:99], v[224:239]
    ds_read_b64_tr_b16 v[64:65], v17 offset:18432
    ds_read_b64_tr_b16 v[66:67], v17 offset:18944
    s_waitcnt lgkmcnt(5)
    ds_read_b64_tr_b16 v[52:53], v18 offset:17408
    v_mfma_f32_32x32x16_bf16 v[176:191], v[100:103], v[96:99], v[176:191]
    ds_read_b64_tr_b16 v[54:55], v18 offset:17664
    ds_read_b64_tr_b16 v[56:57], v18 offset:21504
    ds_read_b64_tr_b16 v[58:59], v18 offset:21760
    v_mfma_f32_32x32x16_bf16 v[192:207], v[104:107], v[96:99], v[192:207]
    v_mfma_f32_32x32x16_bf16 v[208:223], v[36:39], v[24:27], v[208:223]
    ds_read_b128 v[72:75], v10 offset:49152
    ds_read_b64_tr_b16 v[84:85], v16 offset:20480
    ds_read_b64_tr_b16 v[86:87], v16 offset:20992
    v_mfma_f32_32x32x16_bf16 v[224:239], v[40:43], v[24:27], v[224:239]
    ds_read_b64_tr_b16 v[88:89], v17 offset:20480
    ds_read_b64_tr_b16 v[90:91], v17 offset:20992
    s_waitcnt lgkmcnt(5)
    ds_read_b64_tr_b16 v[76:77], v18 offset:18432
    v_mfma_f32_32x32x16_bf16 v[176:191], v[28:31], v[24:27], v[176:191]
    ds_read_b64_tr_b16 v[78:79], v18 offset:18688
    ds_read_b64_tr_b16 v[80:81], v18 offset:22528
    ds_read_b64_tr_b16 v[82:83], v18 offset:22784
    v_mfma_f32_32x32x16_bf16 v[192:207], v[32:35], v[24:27], v[192:207]
    s_cmp_lg_u32 s63, 0
    s_cbranch_scc1 gated_mix__softmax_full_mha__sliding_block__prompt_kernel_k_fa_8
    s_getreg_b32 s45, hwreg(HW_REG_IB_STS)
    s_and_b32 s45, s45, 0x00c0000f
    s_cbranch_scc1 gated_mix__softmax_full_mha__sliding_block__prompt_kernel_k_fa_8
    s_mov_b64 exec, 1
    buffer_store_dwordx2 v[172:173], v174, s[28:31], s62 offen sc1
    s_mov_b64 exec, -1
    s_mov_b32 s63, 1
gated_mix__softmax_full_mha__sliding_block__prompt_kernel_k_fa_8:
    v_mfma_f32_32x32x16_bf16 v[208:223], v[60:63], v[48:51], v[208:223]
    ds_read_b128 v[96:99], v11 offset:49152
    ds_read_b64_tr_b16 v[108:109], v16 offset:22528
    ds_read_b64_tr_b16 v[110:111], v16 offset:23040
    v_mfma_f32_32x32x16_bf16 v[224:239], v[64:67], v[48:51], v[224:239]
    ds_read_b64_tr_b16 v[112:113], v17 offset:22528
    ds_read_b64_tr_b16 v[114:115], v17 offset:23040
    s_waitcnt lgkmcnt(5)
    ds_read_b64_tr_b16 v[100:101], v18 offset:19456
    v_mfma_f32_32x32x16_bf16 v[176:191], v[52:55], v[48:51], v[176:191]
    ds_read_b64_tr_b16 v[102:103], v18 offset:19712
    ds_read_b64_tr_b16 v[104:105], v18 offset:23552
    ds_read_b64_tr_b16 v[106:107], v18 offset:23808
    v_mfma_f32_32x32x16_bf16 v[192:207], v[56:59], v[48:51], v[192:207]
    s_waitcnt lgkmcnt(0)
    s_barrier
    v_mfma_f32_32x32x16_bf16 v[208:223], v[84:87], v[72:75], v[208:223]
    ds_read_b128 v[24:27], v12 offset:0
    ds_read_b64_tr_b16 v[36:37], v16 offset:32768
    ds_read_b64_tr_b16 v[38:39], v16 offset:33280
    v_mfma_f32_32x32x16_bf16 v[224:239], v[88:91], v[72:75], v[224:239]
    ds_read_b64_tr_b16 v[40:41], v17 offset:32768
    ds_read_b64_tr_b16 v[42:43], v17 offset:33280
    ds_read_b64_tr_b16 v[28:29], v18 offset:32768
    v_mfma_f32_32x32x16_bf16 v[176:191], v[76:79], v[72:75], v[176:191]
    ds_read_b64_tr_b16 v[30:31], v18 offset:33024
    ds_read_b64_tr_b16 v[32:33], v18 offset:36864
    ds_read_b64_tr_b16 v[34:35], v18 offset:37120
    v_mfma_f32_32x32x16_bf16 v[192:207], v[80:83], v[72:75], v[192:207]
    s_cmp_lg_u32 s63, 0
    s_cbranch_scc1 gated_mix__softmax_full_mha__sliding_block__prompt_kernel_k_fa_9
    s_getreg_b32 s45, hwreg(HW_REG_IB_STS)
    s_and_b32 s45, s45, 0x00c0000f
    s_cbranch_scc1 gated_mix__softmax_full_mha__sliding_block__prompt_kernel_k_fa_9
    s_mov_b64 exec, 1
    buffer_store_dwordx2 v[172:173], v174, s[28:31], s62 offen sc1
    s_mov_b64 exec, -1
    s_mov_b32 s63, 1
gated_mix__softmax_full_mha__sliding_block__prompt_kernel_k_fa_9:
    v_mfma_f32_32x32x16_bf16 v[208:223], v[108:111], v[96:99], v[208:223]
    ds_read_b128 v[48:51], v13 offset:0
    ds_read_b64_tr_b16 v[60:61], v16 offset:34816
    ds_read_b64_tr_b16 v[62:63], v16 offset:35328
    v_mfma_f32_32x32x16_bf16 v[224:239], v[112:115], v[96:99], v[224:239]
    ds_read_b64_tr_b16 v[64:65], v17 offset:34816
    ds_read_b64_tr_b16 v[66:67], v17 offset:35328
    s_waitcnt lgkmcnt(5)
    ds_read_b64_tr_b16 v[52:53], v18 offset:33792
    v_mfma_f32_32x32x16_bf16 v[176:191], v[100:103], v[96:99], v[176:191]
    ds_read_b64_tr_b16 v[54:55], v18 offset:34048
    ds_read_b64_tr_b16 v[56:57], v18 offset:37888
    ds_read_b64_tr_b16 v[58:59], v18 offset:38144
    v_mfma_f32_32x32x16_bf16 v[192:207], v[104:107], v[96:99], v[192:207]
    v_mfma_f32_32x32x16_bf16 v[208:223], v[36:39], v[24:27], v[208:223]
    ds_read_b128 v[72:75], v14 offset:0
    ds_read_b64_tr_b16 v[84:85], v16 offset:36864
    ds_read_b64_tr_b16 v[86:87], v16 offset:37376
    v_mfma_f32_32x32x16_bf16 v[224:239], v[40:43], v[24:27], v[224:239]
    ds_read_b64_tr_b16 v[88:89], v17 offset:36864
    ds_read_b64_tr_b16 v[90:91], v17 offset:37376
    s_waitcnt lgkmcnt(5)
    ds_read_b64_tr_b16 v[76:77], v18 offset:34816
    v_mfma_f32_32x32x16_bf16 v[176:191], v[28:31], v[24:27], v[176:191]
    ds_read_b64_tr_b16 v[78:79], v18 offset:35072
    ds_read_b64_tr_b16 v[80:81], v18 offset:38912
    ds_read_b64_tr_b16 v[82:83], v18 offset:39168
    v_mfma_f32_32x32x16_bf16 v[192:207], v[32:35], v[24:27], v[192:207]
    s_cmp_lg_u32 s63, 0
    s_cbranch_scc1 gated_mix__softmax_full_mha__sliding_block__prompt_kernel_k_fa_10
    s_getreg_b32 s45, hwreg(HW_REG_IB_STS)
    s_and_b32 s45, s45, 0x00c0000f
    s_cbranch_scc1 gated_mix__softmax_full_mha__sliding_block__prompt_kernel_k_fa_10
    s_mov_b64 exec, 1
    buffer_store_dwordx2 v[172:173], v174, s[28:31], s62 offen sc1
    s_mov_b64 exec, -1
    s_mov_b32 s63, 1
gated_mix__softmax_full_mha__sliding_block__prompt_kernel_k_fa_10:
    v_mfma_f32_32x32x16_bf16 v[208:223], v[60:63], v[48:51], v[208:223]
    ds_read_b128 v[96:99], v15 offset:0
    ds_read_b64_tr_b16 v[108:109], v16 offset:38912
    ds_read_b64_tr_b16 v[110:111], v16 offset:39424
    v_mfma_f32_32x32x16_bf16 v[224:239], v[64:67], v[48:51], v[224:239]
    ds_read_b64_tr_b16 v[112:113], v17 offset:38912
    ds_read_b64_tr_b16 v[114:115], v17 offset:39424
    s_waitcnt lgkmcnt(5)
    ds_read_b64_tr_b16 v[100:101], v18 offset:35840
    v_mfma_f32_32x32x16_bf16 v[176:191], v[52:55], v[48:51], v[176:191]
    ds_read_b64_tr_b16 v[102:103], v18 offset:36096
    ds_read_b64_tr_b16 v[104:105], v18 offset:39936
    ds_read_b64_tr_b16 v[106:107], v18 offset:40192
    v_mfma_f32_32x32x16_bf16 v[192:207], v[56:59], v[48:51], v[192:207]
    s_waitcnt lgkmcnt(0)
    s_barrier
    v_mfma_f32_32x32x16_bf16 v[208:223], v[84:87], v[72:75], v[208:223]
    ds_read_b128 v[24:27], v8 offset:0
    ds_read_b64_tr_b16 v[36:37], v16 offset:49152
    ds_read_b64_tr_b16 v[38:39], v16 offset:49664
    v_mfma_f32_32x32x16_bf16 v[224:239], v[88:91], v[72:75], v[224:239]
    ds_read_b64_tr_b16 v[40:41], v17 offset:49152
    ds_read_b64_tr_b16 v[42:43], v17 offset:49664
    ds_read_b64_tr_b16 v[28:29], v18 offset:49152
    v_mfma_f32_32x32x16_bf16 v[176:191], v[76:79], v[72:75], v[176:191]
    ds_read_b64_tr_b16 v[30:31], v18 offset:49408
    ds_read_b64_tr_b16 v[32:33], v18 offset:53248
    ds_read_b64_tr_b16 v[34:35], v18 offset:53504
    v_mfma_f32_32x32x16_bf16 v[192:207], v[80:83], v[72:75], v[192:207]
    s_cmp_lg_u32 s63, 0
    s_cbranch_scc1 gated_mix__softmax_full_mha__sliding_block__prompt_kernel_k_fa_11
    s_getreg_b32 s45, hwreg(HW_REG_IB_STS)
    s_and_b32 s45, s45, 0x00c0000f
    s_cbranch_scc1 gated_mix__softmax_full_mha__sliding_block__prompt_kernel_k_fa_11
    s_mov_b64 exec, 1
    buffer_store_dwordx2 v[172:173], v174, s[28:31], s62 offen sc1
    s_mov_b64 exec, -1
    s_mov_b32 s63, 1
gated_mix__softmax_full_mha__sliding_block__prompt_kernel_k_fa_11:
    v_mfma_f32_32x32x16_bf16 v[208:223], v[108:111], v[96:99], v[208:223]
    ds_read_b128 v[48:51], v9 offset:0
    ds_read_b64_tr_b16 v[60:61], v16 offset:51200
    ds_read_b64_tr_b16 v[62:63], v16 offset:51712
    v_mfma_f32_32x32x16_bf16 v[224:239], v[112:115], v[96:99], v[224:239]
    ds_read_b64_tr_b16 v[64:65], v17 offset:51200
    ds_read_b64_tr_b16 v[66:67], v17 offset:51712
    s_waitcnt lgkmcnt(5)
    ds_read_b64_tr_b16 v[52:53], v18 offset:50176
    v_mfma_f32_32x32x16_bf16 v[176:191], v[100:103], v[96:99], v[176:191]
    ds_read_b64_tr_b16 v[54:55], v18 offset:50432
    ds_read_b64_tr_b16 v[56:57], v18 offset:54272
    ds_read_b64_tr_b16 v[58:59], v18 offset:54528
    v_mfma_f32_32x32x16_bf16 v[192:207], v[104:107], v[96:99], v[192:207]
    v_mfma_f32_32x32x16_bf16 v[208:223], v[36:39], v[24:27], v[208:223]
    ds_read_b128 v[72:75], v10 offset:0
    ds_read_b64_tr_b16 v[84:85], v16 offset:53248
    ds_read_b64_tr_b16 v[86:87], v16 offset:53760
    v_mfma_f32_32x32x16_bf16 v[224:239], v[40:43], v[24:27], v[224:239]
    ds_read_b64_tr_b16 v[88:89], v17 offset:53248
    ds_read_b64_tr_b16 v[90:91], v17 offset:53760
    s_waitcnt lgkmcnt(5)
    ds_read_b64_tr_b16 v[76:77], v18 offset:51200
    v_mfma_f32_32x32x16_bf16 v[176:191], v[28:31], v[24:27], v[176:191]
    ds_read_b64_tr_b16 v[78:79], v18 offset:51456
    ds_read_b64_tr_b16 v[80:81], v18 offset:55296
    ds_read_b64_tr_b16 v[82:83], v18 offset:55552
    v_mfma_f32_32x32x16_bf16 v[192:207], v[32:35], v[24:27], v[192:207]
    s_cmp_lg_u32 s63, 0
    s_cbranch_scc1 gated_mix__softmax_full_mha__sliding_block__prompt_kernel_k_fa_12
    s_getreg_b32 s45, hwreg(HW_REG_IB_STS)
    s_and_b32 s45, s45, 0x00c0000f
    s_cbranch_scc1 gated_mix__softmax_full_mha__sliding_block__prompt_kernel_k_fa_12
    s_mov_b64 exec, 1
    buffer_store_dwordx2 v[172:173], v174, s[28:31], s62 offen sc1
    s_mov_b64 exec, -1
    s_mov_b32 s63, 1
gated_mix__softmax_full_mha__sliding_block__prompt_kernel_k_fa_12:
    v_mfma_f32_32x32x16_bf16 v[208:223], v[60:63], v[48:51], v[208:223]
    ds_read_b128 v[96:99], v11 offset:0
    ds_read_b64_tr_b16 v[108:109], v16 offset:55296
    ds_read_b64_tr_b16 v[110:111], v16 offset:55808
    v_mfma_f32_32x32x16_bf16 v[224:239], v[64:67], v[48:51], v[224:239]
    ds_read_b64_tr_b16 v[112:113], v17 offset:55296
    ds_read_b64_tr_b16 v[114:115], v17 offset:55808
    s_waitcnt lgkmcnt(5)
    ds_read_b64_tr_b16 v[100:101], v18 offset:52224
    v_mfma_f32_32x32x16_bf16 v[176:191], v[52:55], v[48:51], v[176:191]
    ds_read_b64_tr_b16 v[102:103], v18 offset:52480
    ds_read_b64_tr_b16 v[104:105], v18 offset:56320
    ds_read_b64_tr_b16 v[106:107], v18 offset:56576
    v_mfma_f32_32x32x16_bf16 v[192:207], v[56:59], v[48:51], v[192:207]
    v_mfma_f32_32x32x16_bf16 v[208:223], v[84:87], v[72:75], v[208:223]
    v_mfma_f32_32x32x16_bf16 v[224:239], v[88:91], v[72:75], v[224:239]
    v_mfma_f32_32x32x16_bf16 v[176:191], v[76:79], v[72:75], v[176:191]
    v_mfma_f32_32x32x16_bf16 v[192:207], v[80:83], v[72:75], v[192:207]
    s_cmp_lg_u32 s63, 0
    s_cbranch_scc1 gated_mix__softmax_full_mha__sliding_block__prompt_kernel_k_fa_13
    s_getreg_b32 s45, hwreg(HW_REG_IB_STS)
    s_and_b32 s45, s45, 0x00c0000f
    s_cbranch_scc1 gated_mix__softmax_full_mha__sliding_block__prompt_kernel_k_fa_13
    s_mov_b64 exec, 1
    buffer_store_dwordx2 v[172:173], v174, s[28:31], s62 offen sc1
    s_mov_b64 exec, -1
    s_mov_b32 s63, 1
gated_mix__softmax_full_mha__sliding_block__prompt_kernel_k_fa_13:
    s_waitcnt lgkmcnt(0)
    v_mfma_f32_32x32x16_bf16 v[208:223], v[108:111], v[96:99], v[208:223]
    v_mfma_f32_32x32x16_bf16 v[224:239], v[112:115], v[96:99], v[224:239]
    v_mfma_f32_32x32x16_bf16 v[176:191], v[100:103], v[96:99], v[176:191]
    v_mfma_f32_32x32x16_bf16 v[192:207], v[104:107], v[96:99], v[192:207]
    s_cmp_lg_u32 s63, 0
    s_cbranch_scc1 gated_mix__softmax_full_mha__sliding_block__prompt_kernel_k_fa_14
    s_waitcnt vmcnt(0)
    s_mov_b64 exec, 1
    buffer_store_dwordx2 v[172:173], v174, s[28:31], s62 offen sc1
    s_mov_b64 exec, -1
gated_mix__softmax_full_mha__sliding_block__prompt_kernel_k_fa_14:
    s_barrier
    v_mad_u32_u24 v152, s52, v153, v156
    buffer_load_dwordx4 v[24:27], v157, s[28:31], s52 offen sc1
    buffer_load_dwordx4 v[40:43], v152, s[28:31], 0 offen offset:0 sc1
    buffer_load_dwordx4 v[44:47], v152, s[28:31], 0 offen offset:512 sc1
    s_add_u32 s52, s52, 2048
    s_cmp_eq_u32 s52, s69
    s_cselect_b32 s52, s68, s52
    v_mad_u32_u24 v152, s52, v153, v156
    buffer_load_dwordx4 v[28:31], v157, s[28:31], s52 offen sc1
    buffer_load_dwordx4 v[48:51], v152, s[28:31], 0 offen offset:0 sc1
    buffer_load_dwordx4 v[52:55], v152, s[28:31], 0 offen offset:512 sc1
    s_mov_b32 s48, 0x3eb8aa3b
    s_mov_b32 s49, 0x3eb8aa3b
    s_lshl_b32 s45, s40, 10
    v_pk_mul_f32 v[176:177], v[176:177], s[48:49]
    v_pk_mul_f32 v[178:179], v[178:179], s[48:49]
    v_pk_mul_f32 v[180:181], v[180:181], s[48:49]
    v_pk_mul_f32 v[182:183], v[182:183], s[48:49]
    v_pk_mul_f32 v[184:185], v[184:185], s[48:49]
    v_pk_mul_f32 v[186:187], v[186:187], s[48:49]
    v_pk_mul_f32 v[188:189], v[188:189], s[48:49]
    v_pk_mul_f32 v[190:191], v[190:191], s[48:49]
    v_cvt_pk_bf16_f32 v176, v176, v177
    v_cvt_pk_bf16_f32 v177, v178, v179
    v_cvt_pk_bf16_f32 v178, v180, v181
    v_cvt_pk_bf16_f32 v179, v182, v183
    v_cvt_pk_bf16_f32 v180, v184, v185
    v_cvt_pk_bf16_f32 v181, v186, v187
    v_cvt_pk_bf16_f32 v182, v188, v189
    v_cvt_pk_bf16_f32 v183, v190, v191
    s_add_u32 s46, s45, 147456
    v_add_u32 v4, s46, v157
    ds_write_b128 v4, v[176:179]
    ds_write_b128 v4, v[180:183] offset:4096
    v_pk_mul_f32 v[192:193], v[192:193], s[48:49]
    v_pk_mul_f32 v[194:195], v[194:195], s[48:49]
    v_pk_mul_f32 v[196:197], v[196:197], s[48:49]
    v_pk_mul_f32 v[198:199], v[198:199], s[48:49]
    v_pk_mul_f32 v[200:201], v[200:201], s[48:49]
    v_pk_mul_f32 v[202:203], v[202:203], s[48:49]
    v_pk_mul_f32 v[204:205], v[204:205], s[48:49]
    v_pk_mul_f32 v[206:207], v[206:207], s[48:49]
    v_cvt_pk_bf16_f32 v192, v192, v193
    v_cvt_pk_bf16_f32 v193, v194, v195
    v_cvt_pk_bf16_f32 v194, v196, v197
    v_cvt_pk_bf16_f32 v195, v198, v199
    v_cvt_pk_bf16_f32 v196, v200, v201
    v_cvt_pk_bf16_f32 v197, v202, v203
    v_cvt_pk_bf16_f32 v198, v204, v205
    v_cvt_pk_bf16_f32 v199, v206, v207
    s_add_u32 s46, s45, 155648
    v_add_u32 v4, s46, v157
    ds_write_b128 v4, v[192:195]
    ds_write_b128 v4, v[196:199] offset:4096
    v_cvt_pk_bf16_f32 v8, v208, v209
    v_cvt_pk_bf16_f32 v9, v210, v211
    v_cvt_pk_bf16_f32 v10, v212, v213
    v_cvt_pk_bf16_f32 v11, v214, v215
    v_cvt_pk_bf16_f32 v12, v216, v217
    v_cvt_pk_bf16_f32 v13, v218, v219
    v_cvt_pk_bf16_f32 v14, v220, v221
    v_cvt_pk_bf16_f32 v15, v222, v223
    v_cvt_pk_bf16_f32 v16, v224, v225
    v_cvt_pk_bf16_f32 v17, v226, v227
    v_cvt_pk_bf16_f32 v18, v228, v229
    v_cvt_pk_bf16_f32 v19, v230, v231
    v_cvt_pk_bf16_f32 v20, v232, v233
    v_cvt_pk_bf16_f32 v21, v234, v235
    v_cvt_pk_bf16_f32 v22, v236, v237
    v_cvt_pk_bf16_f32 v23, v238, v239
    s_add_u32 s70, s70, 4194304
    s_add_u32 s71, s71, 4194304
    s_add_u32 s64, s64, 4194304
    s_add_u32 s65, s65, 4194304
    s_lshl_b32 s45, s40, 7
    s_add_u32 s45, s45, 104448
    v_and_b32 v5, 31, v1
    v_lshlrev_b32 v5, 2, v5
    v_add_u32 v5, s45, v5
    ds_write_b32 v5, v241
    s_branch gated_mix__softmax_full_mha__sliding_block__prompt_kernel_attn
gated_mix__softmax_full_mha__sliding_block__prompt_kernel_vtype:
    v_bfe_u32 v4, v1, 4, 1
    v_lshlrev_b32 v4, 17, v4
    v_lshl_add_u32 v4, v3, 8, v4
    v_and_b32 v5, 15, v1
    v_lshl_add_u32 v167, v5, 4, v4
    s_add_u32 s70, s45, 1024
    s_add_u32 s71, s45, 1536
    s_add_u32 s64, s45, 263168
    s_add_u32 s65, s45, 263680
    s_barrier
    ds_read_b128 v[24:27], v8 offset:0
    ds_read_b64_tr_b16 v[28:29], v16 offset:0
    ds_read_b64_tr_b16 v[30:31], v16 offset:512
    ds_read_b64_tr_b16 v[32:33], v17 offset:0
    ds_read_b64_tr_b16 v[34:35], v17 offset:512
    ds_read_b128 v[44:47], v19 offset:0
    ds_read_b128 v[48:51], v9 offset:0
    ds_read_b64_tr_b16 v[52:53], v16 offset:2048
    ds_read_b64_tr_b16 v[54:55], v16 offset:2560
    ds_read_b64_tr_b16 v[56:57], v17 offset:2048
    ds_read_b64_tr_b16 v[58:59], v17 offset:2560
    ds_read_b128 v[68:71], v19 offset:32
    s_waitcnt lgkmcnt(6)
    v_mfma_f32_32x32x16_bf16 v[120:135], v[24:27], v[28:31], 0
    ds_read_b128 v[72:75], v10 offset:0
    ds_read_b64_tr_b16 v[76:77], v16 offset:4096
    v_mfma_f32_32x32x16_bf16 v[136:151], v[24:27], v[32:35], 0
    ds_read_b64_tr_b16 v[78:79], v16 offset:4608
    ds_read_b64_tr_b16 v[80:81], v17 offset:4096
    v_mfma_f32_32x32x16_bf16 v[240:255], v[44:47], v[24:27], 0
    ds_read_b64_tr_b16 v[82:83], v17 offset:4608
    ds_read_b128 v[92:95], v19 offset:64
    s_waitcnt lgkmcnt(6)
    v_mfma_f32_32x32x16_bf16 v[120:135], v[48:51], v[52:55], v[120:135]
    ds_read_b128 v[96:99], v11 offset:0
    ds_read_b64_tr_b16 v[100:101], v16 offset:6144
    v_mfma_f32_32x32x16_bf16 v[136:151], v[48:51], v[56:59], v[136:151]
    ds_read_b64_tr_b16 v[102:103], v16 offset:6656
    ds_read_b64_tr_b16 v[104:105], v17 offset:6144
    v_mfma_f32_32x32x16_bf16 v[240:255], v[68:71], v[48:51], v[240:255]
    ds_read_b64_tr_b16 v[106:107], v17 offset:6656
    ds_read_b128 v[116:119], v19 offset:96
    s_waitcnt lgkmcnt(0)
    s_barrier
    v_mfma_f32_32x32x16_bf16 v[120:135], v[72:75], v[76:79], v[120:135]
    ds_read_b128 v[24:27], v8 offset:16384
    ds_read_b64_tr_b16 v[28:29], v16 offset:16384
    v_mfma_f32_32x32x16_bf16 v[136:151], v[72:75], v[80:83], v[136:151]
    ds_read_b64_tr_b16 v[30:31], v16 offset:16896
    ds_read_b64_tr_b16 v[32:33], v17 offset:16384
    v_mfma_f32_32x32x16_bf16 v[240:255], v[92:95], v[72:75], v[240:255]
    ds_read_b64_tr_b16 v[34:35], v17 offset:16896
    ds_read_b128 v[44:47], v19 offset:128
    v_mfma_f32_32x32x16_bf16 v[120:135], v[96:99], v[100:103], v[120:135]
    ds_read_b128 v[48:51], v9 offset:16384
    ds_read_b64_tr_b16 v[52:53], v16 offset:18432
    v_mfma_f32_32x32x16_bf16 v[136:151], v[96:99], v[104:107], v[136:151]
    ds_read_b64_tr_b16 v[54:55], v16 offset:18944
    ds_read_b64_tr_b16 v[56:57], v17 offset:18432
    v_mfma_f32_32x32x16_bf16 v[240:255], v[116:119], v[96:99], v[240:255]
    ds_read_b64_tr_b16 v[58:59], v17 offset:18944
    ds_read_b128 v[68:71], v19 offset:160
    s_waitcnt lgkmcnt(6)
    v_mfma_f32_32x32x16_bf16 v[120:135], v[24:27], v[28:31], v[120:135]
    ds_read_b128 v[72:75], v10 offset:16384
    ds_read_b64_tr_b16 v[76:77], v16 offset:20480
    v_mfma_f32_32x32x16_bf16 v[136:151], v[24:27], v[32:35], v[136:151]
    ds_read_b64_tr_b16 v[78:79], v16 offset:20992
    ds_read_b64_tr_b16 v[80:81], v17 offset:20480
    v_mfma_f32_32x32x16_bf16 v[240:255], v[44:47], v[24:27], v[240:255]
    ds_read_b64_tr_b16 v[82:83], v17 offset:20992
    ds_read_b128 v[92:95], v19 offset:192
    s_waitcnt lgkmcnt(6)
    v_mfma_f32_32x32x16_bf16 v[120:135], v[48:51], v[52:55], v[120:135]
    ds_read_b128 v[96:99], v11 offset:16384
    ds_read_b64_tr_b16 v[100:101], v16 offset:22528
    v_mfma_f32_32x32x16_bf16 v[136:151], v[48:51], v[56:59], v[136:151]
    ds_read_b64_tr_b16 v[102:103], v16 offset:23040
    ds_read_b64_tr_b16 v[104:105], v17 offset:22528
    v_mfma_f32_32x32x16_bf16 v[240:255], v[68:71], v[48:51], v[240:255]
    ds_read_b64_tr_b16 v[106:107], v17 offset:23040
    ds_read_b128 v[116:119], v19 offset:224
    s_waitcnt lgkmcnt(0)
    s_barrier
    v_mfma_f32_32x32x16_bf16 v[120:135], v[72:75], v[76:79], v[120:135]
    ds_read_b128 v[24:27], v8 offset:32768
    ds_read_b64_tr_b16 v[28:29], v16 offset:32768
    v_mfma_f32_32x32x16_bf16 v[136:151], v[72:75], v[80:83], v[136:151]
    ds_read_b64_tr_b16 v[30:31], v16 offset:33280
    ds_read_b64_tr_b16 v[32:33], v17 offset:32768
    v_mfma_f32_32x32x16_bf16 v[240:255], v[92:95], v[72:75], v[240:255]
    ds_read_b64_tr_b16 v[34:35], v17 offset:33280
    ds_read_b128 v[44:47], v19 offset:256
    s_cmp_lg_u32 s40, 1
    s_cbranch_scc1 gated_mix__softmax_full_mha__sliding_block__prompt_kernel_v_wpf_15
    s_and_b32 s45, s41, 1
    s_lshl_b32 s45, s45, 3
    s_and_b32 s46, s42, 7
    s_add_u32 s45, s45, s46
    s_and_b32 s46, s45, 3
    s_lshl_b32 s46, s46, 7
    v_add_u32 v4, s46, v1
    v_mul_u32_u24 v4, 3072, v4
    v_add_u32 v5, 196608, v4
    s_lshr_b32 s45, s45, 2
    s_lshr_b32 s46, s41, 1
    s_lshl_b32 s46, s46, 7
    s_cmp_eq_u32 s45, 0
    s_cbranch_scc0 gated_mix__softmax_full_mha__sliding_block__prompt_kernel_v_wpf_15_b
    buffer_load_dword v163, v4, s[24:27], s46 offen
    buffer_load_dword v162, v5, s[24:27], s46 offen
    s_branch gated_mix__softmax_full_mha__sliding_block__prompt_kernel_v_wpf_15
gated_mix__softmax_full_mha__sliding_block__prompt_kernel_v_wpf_15_b:
    s_sub_u32 s45, s45, 1
    s_lshl_b32 s45, s45, 10
    s_add_u32 s46, s46, s45
    buffer_load_dword v163, v4, s[32:35], s46 offen
    buffer_load_dword v162, v5, s[32:35], s46 offen
gated_mix__softmax_full_mha__sliding_block__prompt_kernel_v_wpf_15:
    v_mfma_f32_32x32x16_bf16 v[120:135], v[96:99], v[100:103], v[120:135]
    ds_read_b128 v[48:51], v9 offset:32768
    ds_read_b64_tr_b16 v[52:53], v16 offset:34816
    v_mfma_f32_32x32x16_bf16 v[136:151], v[96:99], v[104:107], v[136:151]
    ds_read_b64_tr_b16 v[54:55], v16 offset:35328
    ds_read_b64_tr_b16 v[56:57], v17 offset:34816
    v_mfma_f32_32x32x16_bf16 v[240:255], v[116:119], v[96:99], v[240:255]
    ds_read_b64_tr_b16 v[58:59], v17 offset:35328
    ds_read_b128 v[68:71], v19 offset:288
    s_waitcnt lgkmcnt(6)
    v_mfma_f32_32x32x16_bf16 v[120:135], v[24:27], v[28:31], v[120:135]
    ds_read_b128 v[72:75], v10 offset:32768
    ds_read_b64_tr_b16 v[76:77], v16 offset:36864
    v_mfma_f32_32x32x16_bf16 v[136:151], v[24:27], v[32:35], v[136:151]
    ds_read_b64_tr_b16 v[78:79], v16 offset:37376
    ds_read_b64_tr_b16 v[80:81], v17 offset:36864
    v_mfma_f32_32x32x16_bf16 v[240:255], v[44:47], v[24:27], v[240:255]
    ds_read_b64_tr_b16 v[82:83], v17 offset:37376
    ds_read_b128 v[92:95], v19 offset:320
    s_waitcnt lgkmcnt(6)
    v_mfma_f32_32x32x16_bf16 v[120:135], v[48:51], v[52:55], v[120:135]
    ds_read_b128 v[96:99], v11 offset:32768
    ds_read_b64_tr_b16 v[100:101], v16 offset:38912
    v_mfma_f32_32x32x16_bf16 v[136:151], v[48:51], v[56:59], v[136:151]
    ds_read_b64_tr_b16 v[102:103], v16 offset:39424
    ds_read_b64_tr_b16 v[104:105], v17 offset:38912
    v_mfma_f32_32x32x16_bf16 v[240:255], v[68:71], v[48:51], v[240:255]
    ds_read_b64_tr_b16 v[106:107], v17 offset:39424
    ds_read_b128 v[116:119], v19 offset:352
    s_waitcnt lgkmcnt(0)
    s_barrier
    v_mfma_f32_32x32x16_bf16 v[120:135], v[72:75], v[76:79], v[120:135]
    ds_read_b128 v[24:27], v8 offset:49152
    ds_read_b64_tr_b16 v[28:29], v16 offset:49152
    v_mfma_f32_32x32x16_bf16 v[136:151], v[72:75], v[80:83], v[136:151]
    ds_read_b64_tr_b16 v[30:31], v16 offset:49664
    ds_read_b64_tr_b16 v[32:33], v17 offset:49152
    v_mfma_f32_32x32x16_bf16 v[240:255], v[92:95], v[72:75], v[240:255]
    ds_read_b64_tr_b16 v[34:35], v17 offset:49664
    ds_read_b128 v[44:47], v19 offset:384
    v_mfma_f32_32x32x16_bf16 v[120:135], v[96:99], v[100:103], v[120:135]
    ds_read_b128 v[48:51], v9 offset:49152
    ds_read_b64_tr_b16 v[52:53], v16 offset:51200
    v_mfma_f32_32x32x16_bf16 v[136:151], v[96:99], v[104:107], v[136:151]
    ds_read_b64_tr_b16 v[54:55], v16 offset:51712
    ds_read_b64_tr_b16 v[56:57], v17 offset:51200
    v_mfma_f32_32x32x16_bf16 v[240:255], v[116:119], v[96:99], v[240:255]
    ds_read_b64_tr_b16 v[58:59], v17 offset:51712
    ds_read_b128 v[68:71], v19 offset:416
    s_waitcnt lgkmcnt(6)
    v_mfma_f32_32x32x16_bf16 v[120:135], v[24:27], v[28:31], v[120:135]
    ds_read_b128 v[72:75], v10 offset:49152
    ds_read_b64_tr_b16 v[76:77], v16 offset:53248
    v_mfma_f32_32x32x16_bf16 v[136:151], v[24:27], v[32:35], v[136:151]
    ds_read_b64_tr_b16 v[78:79], v16 offset:53760
    ds_read_b64_tr_b16 v[80:81], v17 offset:53248
    v_mfma_f32_32x32x16_bf16 v[240:255], v[44:47], v[24:27], v[240:255]
    ds_read_b64_tr_b16 v[82:83], v17 offset:53760
    ds_read_b128 v[92:95], v19 offset:448
    s_waitcnt lgkmcnt(6)
    v_mfma_f32_32x32x16_bf16 v[120:135], v[48:51], v[52:55], v[120:135]
    ds_read_b128 v[96:99], v11 offset:49152
    ds_read_b64_tr_b16 v[100:101], v16 offset:55296
    v_mfma_f32_32x32x16_bf16 v[136:151], v[48:51], v[56:59], v[136:151]
    ds_read_b64_tr_b16 v[102:103], v16 offset:55808
    ds_read_b64_tr_b16 v[104:105], v17 offset:55296
    v_mfma_f32_32x32x16_bf16 v[240:255], v[68:71], v[48:51], v[240:255]
    ds_read_b64_tr_b16 v[106:107], v17 offset:55808
    ds_read_b128 v[116:119], v19 offset:480
    s_waitcnt lgkmcnt(0)
    s_barrier
    v_mfma_f32_32x32x16_bf16 v[120:135], v[72:75], v[76:79], v[120:135]
    ds_read_b128 v[24:27], v12 offset:0
    ds_read_b64_tr_b16 v[28:29], v16 offset:0
    v_mfma_f32_32x32x16_bf16 v[136:151], v[72:75], v[80:83], v[136:151]
    ds_read_b64_tr_b16 v[30:31], v16 offset:512
    ds_read_b64_tr_b16 v[32:33], v17 offset:0
    v_mfma_f32_32x32x16_bf16 v[240:255], v[92:95], v[72:75], v[240:255]
    ds_read_b64_tr_b16 v[34:35], v17 offset:512
    ds_read_b128 v[44:47], v19 offset:512
    v_mfma_f32_32x32x16_bf16 v[120:135], v[96:99], v[100:103], v[120:135]
    ds_read_b128 v[48:51], v13 offset:0
    ds_read_b64_tr_b16 v[52:53], v16 offset:2048
    v_mfma_f32_32x32x16_bf16 v[136:151], v[96:99], v[104:107], v[136:151]
    ds_read_b64_tr_b16 v[54:55], v16 offset:2560
    ds_read_b64_tr_b16 v[56:57], v17 offset:2048
    v_mfma_f32_32x32x16_bf16 v[240:255], v[116:119], v[96:99], v[240:255]
    ds_read_b64_tr_b16 v[58:59], v17 offset:2560
    ds_read_b128 v[68:71], v19 offset:544
    s_waitcnt lgkmcnt(6)
    v_mfma_f32_32x32x16_bf16 v[120:135], v[24:27], v[28:31], v[120:135]
    ds_read_b128 v[72:75], v14 offset:0
    ds_read_b64_tr_b16 v[76:77], v16 offset:4096
    v_mfma_f32_32x32x16_bf16 v[136:151], v[24:27], v[32:35], v[136:151]
    ds_read_b64_tr_b16 v[78:79], v16 offset:4608
    ds_read_b64_tr_b16 v[80:81], v17 offset:4096
    v_mfma_f32_32x32x16_bf16 v[240:255], v[44:47], v[24:27], v[240:255]
    ds_read_b64_tr_b16 v[82:83], v17 offset:4608
    ds_read_b128 v[92:95], v19 offset:576
    s_waitcnt lgkmcnt(6)
    v_mfma_f32_32x32x16_bf16 v[120:135], v[48:51], v[52:55], v[120:135]
    ds_read_b128 v[96:99], v15 offset:0
    ds_read_b64_tr_b16 v[100:101], v16 offset:6144
    v_mfma_f32_32x32x16_bf16 v[136:151], v[48:51], v[56:59], v[136:151]
    ds_read_b64_tr_b16 v[102:103], v16 offset:6656
    ds_read_b64_tr_b16 v[104:105], v17 offset:6144
    v_mfma_f32_32x32x16_bf16 v[240:255], v[68:71], v[48:51], v[240:255]
    ds_read_b64_tr_b16 v[106:107], v17 offset:6656
    ds_read_b128 v[116:119], v19 offset:608
    s_waitcnt lgkmcnt(0)
    s_barrier
    v_mfma_f32_32x32x16_bf16 v[120:135], v[72:75], v[76:79], v[120:135]
    ds_read_b128 v[24:27], v8 offset:0
    ds_read_b64_tr_b16 v[28:29], v16 offset:16384
    v_mfma_f32_32x32x16_bf16 v[136:151], v[72:75], v[80:83], v[136:151]
    ds_read_b64_tr_b16 v[30:31], v16 offset:16896
    ds_read_b64_tr_b16 v[32:33], v17 offset:16384
    v_mfma_f32_32x32x16_bf16 v[240:255], v[92:95], v[72:75], v[240:255]
    ds_read_b64_tr_b16 v[34:35], v17 offset:16896
    ds_read_b128 v[44:47], v19 offset:640
    v_mfma_f32_32x32x16_bf16 v[120:135], v[96:99], v[100:103], v[120:135]
    ds_read_b128 v[48:51], v9 offset:0
    ds_read_b64_tr_b16 v[52:53], v16 offset:18432
    v_mfma_f32_32x32x16_bf16 v[136:151], v[96:99], v[104:107], v[136:151]
    ds_read_b64_tr_b16 v[54:55], v16 offset:18944
    ds_read_b64_tr_b16 v[56:57], v17 offset:18432
    v_mfma_f32_32x32x16_bf16 v[240:255], v[116:119], v[96:99], v[240:255]
    ds_read_b64_tr_b16 v[58:59], v17 offset:18944
    ds_read_b128 v[68:71], v19 offset:672
    s_waitcnt lgkmcnt(6)
    v_mfma_f32_32x32x16_bf16 v[120:135], v[24:27], v[28:31], v[120:135]
    ds_read_b128 v[72:75], v10 offset:0
    ds_read_b64_tr_b16 v[76:77], v16 offset:20480
    v_mfma_f32_32x32x16_bf16 v[136:151], v[24:27], v[32:35], v[136:151]
    ds_read_b64_tr_b16 v[78:79], v16 offset:20992
    ds_read_b64_tr_b16 v[80:81], v17 offset:20480
    v_mfma_f32_32x32x16_bf16 v[240:255], v[44:47], v[24:27], v[240:255]
    ds_read_b64_tr_b16 v[82:83], v17 offset:20992
    ds_read_b128 v[92:95], v19 offset:704
    s_waitcnt vmcnt(0)
    v_add_co_u32 v172, vcc, 1, v172
    s_nop 1
    v_addc_co_u32 v173, vcc, 0, v173, vcc
    s_lshl_b32 s62, s41, 4
    s_add_u32 s62, s62, s42
    s_lshl_b32 s62, s62, 2
    s_add_u32 s62, s62, s40
    s_lshl_b32 s62, s62, 7
    s_add_u32 s62, s62, 18874368
    s_mov_b32 s63, 0
    s_waitcnt lgkmcnt(6)
    v_mfma_f32_32x32x16_bf16 v[120:135], v[48:51], v[52:55], v[120:135]
    ds_read_b128 v[96:99], v11 offset:0
    ds_read_b64_tr_b16 v[100:101], v16 offset:22528
    v_mfma_f32_32x32x16_bf16 v[136:151], v[48:51], v[56:59], v[136:151]
    ds_read_b64_tr_b16 v[102:103], v16 offset:23040
    ds_read_b64_tr_b16 v[104:105], v17 offset:22528
    v_mfma_f32_32x32x16_bf16 v[240:255], v[68:71], v[48:51], v[240:255]
    ds_read_b64_tr_b16 v[106:107], v17 offset:23040
    ds_read_b128 v[116:119], v19 offset:736
    s_waitcnt lgkmcnt(0)
    s_barrier
    v_mfma_f32_32x32x16_bf16 v[120:135], v[72:75], v[76:79], v[120:135]
    ds_read_b128 v[24:27], v8 offset:16384
    ds_read_b64_tr_b16 v[28:29], v16 offset:32768
    v_mfma_f32_32x32x16_bf16 v[136:151], v[72:75], v[80:83], v[136:151]
    ds_read_b64_tr_b16 v[30:31], v16 offset:33280
    ds_read_b64_tr_b16 v[32:33], v17 offset:32768
    v_mfma_f32_32x32x16_bf16 v[240:255], v[92:95], v[72:75], v[240:255]
    ds_read_b64_tr_b16 v[34:35], v17 offset:33280
    ds_read_b128 v[44:47], v19 offset:768
    v_mfma_f32_32x32x16_bf16 v[120:135], v[96:99], v[100:103], v[120:135]
    ds_read_b128 v[48:51], v9 offset:16384
    ds_read_b64_tr_b16 v[52:53], v16 offset:34816
    v_mfma_f32_32x32x16_bf16 v[136:151], v[96:99], v[104:107], v[136:151]
    ds_read_b64_tr_b16 v[54:55], v16 offset:35328
    ds_read_b64_tr_b16 v[56:57], v17 offset:34816
    v_mfma_f32_32x32x16_bf16 v[240:255], v[116:119], v[96:99], v[240:255]
    ds_read_b64_tr_b16 v[58:59], v17 offset:35328
    ds_read_b128 v[68:71], v19 offset:800
    s_waitcnt lgkmcnt(6)
    v_mfma_f32_32x32x16_bf16 v[120:135], v[24:27], v[28:31], v[120:135]
    ds_read_b128 v[72:75], v10 offset:16384
    ds_read_b64_tr_b16 v[76:77], v16 offset:36864
    v_mfma_f32_32x32x16_bf16 v[136:151], v[24:27], v[32:35], v[136:151]
    ds_read_b64_tr_b16 v[78:79], v16 offset:37376
    ds_read_b64_tr_b16 v[80:81], v17 offset:36864
    v_mfma_f32_32x32x16_bf16 v[240:255], v[44:47], v[24:27], v[240:255]
    ds_read_b64_tr_b16 v[82:83], v17 offset:37376
    ds_read_b128 v[92:95], v19 offset:832
    s_waitcnt lgkmcnt(6)
    v_mfma_f32_32x32x16_bf16 v[120:135], v[48:51], v[52:55], v[120:135]
    ds_read_b128 v[96:99], v11 offset:16384
    ds_read_b64_tr_b16 v[100:101], v16 offset:38912
    v_mfma_f32_32x32x16_bf16 v[136:151], v[48:51], v[56:59], v[136:151]
    ds_read_b64_tr_b16 v[102:103], v16 offset:39424
    ds_read_b64_tr_b16 v[104:105], v17 offset:38912
    v_mfma_f32_32x32x16_bf16 v[240:255], v[68:71], v[48:51], v[240:255]
    ds_read_b64_tr_b16 v[106:107], v17 offset:39424
    ds_read_b128 v[116:119], v19 offset:864
    s_waitcnt lgkmcnt(0)
    s_barrier
    v_mfma_f32_32x32x16_bf16 v[120:135], v[72:75], v[76:79], v[120:135]
    ds_read_b128 v[24:27], v8 offset:32768
    ds_read_b64_tr_b16 v[28:29], v16 offset:49152
    v_mfma_f32_32x32x16_bf16 v[136:151], v[72:75], v[80:83], v[136:151]
    ds_read_b64_tr_b16 v[30:31], v16 offset:49664
    ds_read_b64_tr_b16 v[32:33], v17 offset:49152
    v_mfma_f32_32x32x16_bf16 v[240:255], v[92:95], v[72:75], v[240:255]
    ds_read_b64_tr_b16 v[34:35], v17 offset:49664
    ds_read_b128 v[44:47], v19 offset:896
    v_mfma_f32_32x32x16_bf16 v[120:135], v[96:99], v[100:103], v[120:135]
    ds_read_b128 v[48:51], v9 offset:32768
    ds_read_b64_tr_b16 v[52:53], v16 offset:51200
    v_mfma_f32_32x32x16_bf16 v[136:151], v[96:99], v[104:107], v[136:151]
    ds_read_b64_tr_b16 v[54:55], v16 offset:51712
    ds_read_b64_tr_b16 v[56:57], v17 offset:51200
    v_mfma_f32_32x32x16_bf16 v[240:255], v[116:119], v[96:99], v[240:255]
    ds_read_b64_tr_b16 v[58:59], v17 offset:51712
    ds_read_b128 v[68:71], v19 offset:928
    s_waitcnt lgkmcnt(6)
    v_mfma_f32_32x32x16_bf16 v[120:135], v[24:27], v[28:31], v[120:135]
    ds_read_b128 v[72:75], v10 offset:32768
    ds_read_b64_tr_b16 v[76:77], v16 offset:53248
    v_mfma_f32_32x32x16_bf16 v[136:151], v[24:27], v[32:35], v[136:151]
    ds_read_b64_tr_b16 v[78:79], v16 offset:53760
    ds_read_b64_tr_b16 v[80:81], v17 offset:53248
    v_mfma_f32_32x32x16_bf16 v[240:255], v[44:47], v[24:27], v[240:255]
    ds_read_b64_tr_b16 v[82:83], v17 offset:53760
    ds_read_b128 v[92:95], v19 offset:960
    s_waitcnt lgkmcnt(6)
    v_mfma_f32_32x32x16_bf16 v[120:135], v[48:51], v[52:55], v[120:135]
    ds_read_b128 v[96:99], v11 offset:32768
    ds_read_b64_tr_b16 v[100:101], v16 offset:55296
    v_mfma_f32_32x32x16_bf16 v[136:151], v[48:51], v[56:59], v[136:151]
    ds_read_b64_tr_b16 v[102:103], v16 offset:55808
    ds_read_b64_tr_b16 v[104:105], v17 offset:55296
    v_mfma_f32_32x32x16_bf16 v[240:255], v[68:71], v[48:51], v[240:255]
    ds_read_b64_tr_b16 v[106:107], v17 offset:55808
    ds_read_b128 v[116:119], v19 offset:992
    s_waitcnt lgkmcnt(0)
    s_barrier
    v_mfma_f32_32x32x16_bf16 v[120:135], v[72:75], v[76:79], v[120:135]
    ds_read_b128 v[24:27], v8 offset:49152
    ds_read_b64_tr_b16 v[36:37], v16 offset:0
    ds_read_b64_tr_b16 v[38:39], v16 offset:512
    v_mfma_f32_32x32x16_bf16 v[136:151], v[72:75], v[80:83], v[136:151]
    ds_read_b64_tr_b16 v[40:41], v17 offset:0
    ds_read_b64_tr_b16 v[42:43], v17 offset:512
    ds_read_b64_tr_b16 v[28:29], v18 offset:0
    v_mfma_f32_32x32x16_bf16 v[240:255], v[92:95], v[72:75], v[240:255]
    ds_read_b64_tr_b16 v[30:31], v18 offset:256
    ds_read_b64_tr_b16 v[32:33], v18 offset:4096
    ds_read_b64_tr_b16 v[34:35], v18 offset:4352
    v_mfma_f32_32x32x16_bf16 v[120:135], v[96:99], v[100:103], v[120:135]
    ds_read_b128 v[48:51], v9 offset:49152
    ds_read_b64_tr_b16 v[60:61], v16 offset:2048
    ds_read_b64_tr_b16 v[62:63], v16 offset:2560
    v_mfma_f32_32x32x16_bf16 v[136:151], v[96:99], v[104:107], v[136:151]
    ds_read_b64_tr_b16 v[64:65], v17 offset:2048
    ds_read_b64_tr_b16 v[66:67], v17 offset:2560
    s_waitcnt lgkmcnt(5)
    ds_read_b64_tr_b16 v[52:53], v18 offset:1024
    v_mfma_f32_32x32x16_bf16 v[240:255], v[116:119], v[96:99], v[240:255]
    ds_read_b64_tr_b16 v[54:55], v18 offset:1280
    ds_read_b64_tr_b16 v[56:57], v18 offset:5120
    ds_read_b64_tr_b16 v[58:59], v18 offset:5376
    v_mfma_f32_32x32x16_bf16 v[208:223], v[24:27], v[36:39], 0
    ds_read_b128 v[72:75], v10 offset:49152
    ds_read_b64_tr_b16 v[84:85], v16 offset:4096
    ds_read_b64_tr_b16 v[86:87], v16 offset:4608
    v_mfma_f32_32x32x16_bf16 v[224:239], v[24:27], v[40:43], 0
    ds_read_b64_tr_b16 v[88:89], v17 offset:4096
    ds_read_b64_tr_b16 v[90:91], v17 offset:4608
    s_waitcnt lgkmcnt(5)
    ds_read_b64_tr_b16 v[76:77], v18 offset:2048
    v_mfma_f32_32x32x16_bf16 v[176:191], v[28:31], v[24:27], 0
    ds_read_b64_tr_b16 v[78:79], v18 offset:2304
    ds_read_b64_tr_b16 v[80:81], v18 offset:6144
    ds_read_b64_tr_b16 v[82:83], v18 offset:6400
    v_mfma_f32_32x32x16_bf16 v[192:207], v[32:35], v[24:27], 0
    v_cvt_pk_bf16_f32 v120, v120, v121
    v_cvt_pk_bf16_f32 v121, v122, v123
    v_cvt_pk_bf16_f32 v122, v124, v125
    v_cvt_pk_bf16_f32 v123, v126, v127
    v_cvt_pk_bf16_f32 v124, v128, v129
    v_cvt_pk_bf16_f32 v125, v130, v131
    v_cvt_pk_bf16_f32 v126, v132, v133
    v_cvt_pk_bf16_f32 v127, v134, v135
    buffer_store_dwordx4 v[120:123], v167, s[28:31], s70 offen sc1
    buffer_store_dwordx4 v[124:127], v167, s[28:31], s71 offen sc1
    v_mfma_f32_32x32x16_bf16 v[208:223], v[48:51], v[60:63], v[208:223]
    ds_read_b128 v[96:99], v11 offset:49152
    ds_read_b64_tr_b16 v[108:109], v16 offset:6144
    ds_read_b64_tr_b16 v[110:111], v16 offset:6656
    v_mfma_f32_32x32x16_bf16 v[224:239], v[48:51], v[64:67], v[224:239]
    ds_read_b64_tr_b16 v[112:113], v17 offset:6144
    ds_read_b64_tr_b16 v[114:115], v17 offset:6656
    s_waitcnt lgkmcnt(5)
    ds_read_b64_tr_b16 v[100:101], v18 offset:3072
    v_mfma_f32_32x32x16_bf16 v[176:191], v[52:55], v[48:51], v[176:191]
    ds_read_b64_tr_b16 v[102:103], v18 offset:3328
    ds_read_b64_tr_b16 v[104:105], v18 offset:7168
    ds_read_b64_tr_b16 v[106:107], v18 offset:7424
    v_mfma_f32_32x32x16_bf16 v[192:207], v[56:59], v[48:51], v[192:207]
    v_cvt_pk_bf16_f32 v136, v136, v137
    v_cvt_pk_bf16_f32 v137, v138, v139
    v_cvt_pk_bf16_f32 v138, v140, v141
    v_cvt_pk_bf16_f32 v139, v142, v143
    v_cvt_pk_bf16_f32 v140, v144, v145
    v_cvt_pk_bf16_f32 v141, v146, v147
    v_cvt_pk_bf16_f32 v142, v148, v149
    v_cvt_pk_bf16_f32 v143, v150, v151
    buffer_store_dwordx4 v[136:139], v167, s[28:31], s64 offen sc1
    buffer_store_dwordx4 v[140:143], v167, s[28:31], s65 offen sc1
    s_waitcnt lgkmcnt(0)
    s_barrier
    v_mfma_f32_32x32x16_bf16 v[208:223], v[72:75], v[84:87], v[208:223]
    ds_read_b128 v[24:27], v12 offset:0
    ds_read_b64_tr_b16 v[36:37], v16 offset:16384
    ds_read_b64_tr_b16 v[38:39], v16 offset:16896
    v_mfma_f32_32x32x16_bf16 v[224:239], v[72:75], v[88:91], v[224:239]
    ds_read_b64_tr_b16 v[40:41], v17 offset:16384
    ds_read_b64_tr_b16 v[42:43], v17 offset:16896
    ds_read_b64_tr_b16 v[28:29], v18 offset:16384
    v_mfma_f32_32x32x16_bf16 v[176:191], v[76:79], v[72:75], v[176:191]
    ds_read_b64_tr_b16 v[30:31], v18 offset:16640
    ds_read_b64_tr_b16 v[32:33], v18 offset:20480
    ds_read_b64_tr_b16 v[34:35], v18 offset:20736
    v_mfma_f32_32x32x16_bf16 v[192:207], v[80:83], v[72:75], v[192:207]
    v_cvt_pk_bf16_f32 v241, v240, v240
    v_lshlrev_b32 v241, 16, v241
    v_mul_f32 v241, 0xbfb8aa3b, v241
    v_exp_f32 v241, v241
    s_nop 0
    v_add_f32 v241, 1.0, v241
    v_rcp_f32 v241, v241
    s_nop 0
    v_cvt_pk_bf16_f32 v241, v241, v241
    v_lshlrev_b32 v241, 16, v241
    v_mfma_f32_32x32x16_bf16 v[208:223], v[96:99], v[108:111], v[208:223]
    ds_read_b128 v[48:51], v13 offset:0
    ds_read_b64_tr_b16 v[60:61], v16 offset:18432
    ds_read_b64_tr_b16 v[62:63], v16 offset:18944
    v_mfma_f32_32x32x16_bf16 v[224:239], v[96:99], v[112:115], v[224:239]
    ds_read_b64_tr_b16 v[64:65], v17 offset:18432
    ds_read_b64_tr_b16 v[66:67], v17 offset:18944
    s_waitcnt lgkmcnt(5)
    ds_read_b64_tr_b16 v[52:53], v18 offset:17408
    v_mfma_f32_32x32x16_bf16 v[176:191], v[100:103], v[96:99], v[176:191]
    ds_read_b64_tr_b16 v[54:55], v18 offset:17664
    ds_read_b64_tr_b16 v[56:57], v18 offset:21504
    ds_read_b64_tr_b16 v[58:59], v18 offset:21760
    v_mfma_f32_32x32x16_bf16 v[192:207], v[104:107], v[96:99], v[192:207]
    v_mfma_f32_32x32x16_bf16 v[208:223], v[24:27], v[36:39], v[208:223]
    ds_read_b128 v[72:75], v14 offset:0
    ds_read_b64_tr_b16 v[84:85], v16 offset:20480
    ds_read_b64_tr_b16 v[86:87], v16 offset:20992
    v_mfma_f32_32x32x16_bf16 v[224:239], v[24:27], v[40:43], v[224:239]
    ds_read_b64_tr_b16 v[88:89], v17 offset:20480
    ds_read_b64_tr_b16 v[90:91], v17 offset:20992
    s_waitcnt lgkmcnt(5)
    ds_read_b64_tr_b16 v[76:77], v18 offset:18432
    v_mfma_f32_32x32x16_bf16 v[176:191], v[28:31], v[24:27], v[176:191]
    ds_read_b64_tr_b16 v[78:79], v18 offset:18688
    ds_read_b64_tr_b16 v[80:81], v18 offset:22528
    ds_read_b64_tr_b16 v[82:83], v18 offset:22784
    v_mfma_f32_32x32x16_bf16 v[192:207], v[32:35], v[24:27], v[192:207]
    v_mfma_f32_32x32x16_bf16 v[208:223], v[48:51], v[60:63], v[208:223]
    ds_read_b128 v[96:99], v15 offset:0
    ds_read_b64_tr_b16 v[108:109], v16 offset:22528
    ds_read_b64_tr_b16 v[110:111], v16 offset:23040
    v_mfma_f32_32x32x16_bf16 v[224:239], v[48:51], v[64:67], v[224:239]
    ds_read_b64_tr_b16 v[112:113], v17 offset:22528
    ds_read_b64_tr_b16 v[114:115], v17 offset:23040
    s_waitcnt lgkmcnt(5)
    ds_read_b64_tr_b16 v[100:101], v18 offset:19456
    v_mfma_f32_32x32x16_bf16 v[176:191], v[52:55], v[48:51], v[176:191]
    ds_read_b64_tr_b16 v[102:103], v18 offset:19712
    ds_read_b64_tr_b16 v[104:105], v18 offset:23552
    ds_read_b64_tr_b16 v[106:107], v18 offset:23808
    v_mfma_f32_32x32x16_bf16 v[192:207], v[56:59], v[48:51], v[192:207]
    s_waitcnt lgkmcnt(0)
    s_barrier
    v_mfma_f32_32x32x16_bf16 v[208:223], v[72:75], v[84:87], v[208:223]
    ds_read_b128 v[24:27], v8 offset:0
    ds_read_b64_tr_b16 v[36:37], v16 offset:32768
    ds_read_b64_tr_b16 v[38:39], v16 offset:33280
    v_mfma_f32_32x32x16_bf16 v[224:239], v[72:75], v[88:91], v[224:239]
    ds_read_b64_tr_b16 v[40:41], v17 offset:32768
    ds_read_b64_tr_b16 v[42:43], v17 offset:33280
    ds_read_b64_tr_b16 v[28:29], v18 offset:32768
    v_mfma_f32_32x32x16_bf16 v[176:191], v[76:79], v[72:75], v[176:191]
    ds_read_b64_tr_b16 v[30:31], v18 offset:33024
    ds_read_b64_tr_b16 v[32:33], v18 offset:36864
    ds_read_b64_tr_b16 v[34:35], v18 offset:37120
    v_mfma_f32_32x32x16_bf16 v[192:207], v[80:83], v[72:75], v[192:207]
    v_mfma_f32_32x32x16_bf16 v[208:223], v[96:99], v[108:111], v[208:223]
    ds_read_b128 v[48:51], v9 offset:0
    ds_read_b64_tr_b16 v[60:61], v16 offset:34816
    ds_read_b64_tr_b16 v[62:63], v16 offset:35328
    v_mfma_f32_32x32x16_bf16 v[224:239], v[96:99], v[112:115], v[224:239]
    ds_read_b64_tr_b16 v[64:65], v17 offset:34816
    ds_read_b64_tr_b16 v[66:67], v17 offset:35328
    s_waitcnt lgkmcnt(5)
    ds_read_b64_tr_b16 v[52:53], v18 offset:33792
    v_mfma_f32_32x32x16_bf16 v[176:191], v[100:103], v[96:99], v[176:191]
    ds_read_b64_tr_b16 v[54:55], v18 offset:34048
    ds_read_b64_tr_b16 v[56:57], v18 offset:37888
    ds_read_b64_tr_b16 v[58:59], v18 offset:38144
    v_mfma_f32_32x32x16_bf16 v[192:207], v[104:107], v[96:99], v[192:207]
    v_mfma_f32_32x32x16_bf16 v[208:223], v[24:27], v[36:39], v[208:223]
    ds_read_b128 v[72:75], v10 offset:0
    ds_read_b64_tr_b16 v[84:85], v16 offset:36864
    ds_read_b64_tr_b16 v[86:87], v16 offset:37376
    v_mfma_f32_32x32x16_bf16 v[224:239], v[24:27], v[40:43], v[224:239]
    ds_read_b64_tr_b16 v[88:89], v17 offset:36864
    ds_read_b64_tr_b16 v[90:91], v17 offset:37376
    s_waitcnt lgkmcnt(5)
    ds_read_b64_tr_b16 v[76:77], v18 offset:34816
    v_mfma_f32_32x32x16_bf16 v[176:191], v[28:31], v[24:27], v[176:191]
    ds_read_b64_tr_b16 v[78:79], v18 offset:35072
    ds_read_b64_tr_b16 v[80:81], v18 offset:38912
    ds_read_b64_tr_b16 v[82:83], v18 offset:39168
    v_mfma_f32_32x32x16_bf16 v[192:207], v[32:35], v[24:27], v[192:207]
    s_cmp_lg_u32 s63, 0
    s_cbranch_scc1 gated_mix__softmax_full_mha__sliding_block__prompt_kernel_v_fa_16
    s_getreg_b32 s45, hwreg(HW_REG_IB_STS)
    s_and_b32 s45, s45, 0x00c0000f
    s_cbranch_scc1 gated_mix__softmax_full_mha__sliding_block__prompt_kernel_v_fa_16
    s_mov_b64 exec, 1
    buffer_store_dwordx2 v[172:173], v174, s[28:31], s62 offen sc1
    s_mov_b64 exec, -1
    s_mov_b32 s63, 1
gated_mix__softmax_full_mha__sliding_block__prompt_kernel_v_fa_16:
    v_mfma_f32_32x32x16_bf16 v[208:223], v[48:51], v[60:63], v[208:223]
    ds_read_b128 v[96:99], v11 offset:0
    ds_read_b64_tr_b16 v[108:109], v16 offset:38912
    ds_read_b64_tr_b16 v[110:111], v16 offset:39424
    v_mfma_f32_32x32x16_bf16 v[224:239], v[48:51], v[64:67], v[224:239]
    ds_read_b64_tr_b16 v[112:113], v17 offset:38912
    ds_read_b64_tr_b16 v[114:115], v17 offset:39424
    s_waitcnt lgkmcnt(5)
    ds_read_b64_tr_b16 v[100:101], v18 offset:35840
    v_mfma_f32_32x32x16_bf16 v[176:191], v[52:55], v[48:51], v[176:191]
    ds_read_b64_tr_b16 v[102:103], v18 offset:36096
    ds_read_b64_tr_b16 v[104:105], v18 offset:39936
    ds_read_b64_tr_b16 v[106:107], v18 offset:40192
    v_mfma_f32_32x32x16_bf16 v[192:207], v[56:59], v[48:51], v[192:207]
    s_waitcnt lgkmcnt(0)
    s_barrier
    v_mfma_f32_32x32x16_bf16 v[208:223], v[72:75], v[84:87], v[208:223]
    ds_read_b128 v[24:27], v8 offset:16384
    ds_read_b64_tr_b16 v[36:37], v16 offset:49152
    ds_read_b64_tr_b16 v[38:39], v16 offset:49664
    v_mfma_f32_32x32x16_bf16 v[224:239], v[72:75], v[88:91], v[224:239]
    ds_read_b64_tr_b16 v[40:41], v17 offset:49152
    ds_read_b64_tr_b16 v[42:43], v17 offset:49664
    ds_read_b64_tr_b16 v[28:29], v18 offset:49152
    v_mfma_f32_32x32x16_bf16 v[176:191], v[76:79], v[72:75], v[176:191]
    ds_read_b64_tr_b16 v[30:31], v18 offset:49408
    ds_read_b64_tr_b16 v[32:33], v18 offset:53248
    ds_read_b64_tr_b16 v[34:35], v18 offset:53504
    v_mfma_f32_32x32x16_bf16 v[192:207], v[80:83], v[72:75], v[192:207]
    s_cmp_lg_u32 s63, 0
    s_cbranch_scc1 gated_mix__softmax_full_mha__sliding_block__prompt_kernel_v_fa_17
    s_getreg_b32 s45, hwreg(HW_REG_IB_STS)
    s_and_b32 s45, s45, 0x00c0000f
    s_cbranch_scc1 gated_mix__softmax_full_mha__sliding_block__prompt_kernel_v_fa_17
    s_mov_b64 exec, 1
    buffer_store_dwordx2 v[172:173], v174, s[28:31], s62 offen sc1
    s_mov_b64 exec, -1
    s_mov_b32 s63, 1
gated_mix__softmax_full_mha__sliding_block__prompt_kernel_v_fa_17:
    v_mfma_f32_32x32x16_bf16 v[208:223], v[96:99], v[108:111], v[208:223]
    ds_read_b128 v[48:51], v9 offset:16384
    ds_read_b64_tr_b16 v[60:61], v16 offset:51200
    ds_read_b64_tr_b16 v[62:63], v16 offset:51712
    v_mfma_f32_32x32x16_bf16 v[224:239], v[96:99], v[112:115], v[224:239]
    ds_read_b64_tr_b16 v[64:65], v17 offset:51200
    ds_read_b64_tr_b16 v[66:67], v17 offset:51712
    s_waitcnt lgkmcnt(5)
    ds_read_b64_tr_b16 v[52:53], v18 offset:50176
    v_mfma_f32_32x32x16_bf16 v[176:191], v[100:103], v[96:99], v[176:191]
    ds_read_b64_tr_b16 v[54:55], v18 offset:50432
    ds_read_b64_tr_b16 v[56:57], v18 offset:54272
    ds_read_b64_tr_b16 v[58:59], v18 offset:54528
    v_mfma_f32_32x32x16_bf16 v[192:207], v[104:107], v[96:99], v[192:207]
    v_mfma_f32_32x32x16_bf16 v[208:223], v[24:27], v[36:39], v[208:223]
    ds_read_b128 v[72:75], v10 offset:16384
    ds_read_b64_tr_b16 v[84:85], v16 offset:53248
    ds_read_b64_tr_b16 v[86:87], v16 offset:53760
    v_mfma_f32_32x32x16_bf16 v[224:239], v[24:27], v[40:43], v[224:239]
    ds_read_b64_tr_b16 v[88:89], v17 offset:53248
    ds_read_b64_tr_b16 v[90:91], v17 offset:53760
    s_waitcnt lgkmcnt(5)
    ds_read_b64_tr_b16 v[76:77], v18 offset:51200
    v_mfma_f32_32x32x16_bf16 v[176:191], v[28:31], v[24:27], v[176:191]
    ds_read_b64_tr_b16 v[78:79], v18 offset:51456
    ds_read_b64_tr_b16 v[80:81], v18 offset:55296
    ds_read_b64_tr_b16 v[82:83], v18 offset:55552
    v_mfma_f32_32x32x16_bf16 v[192:207], v[32:35], v[24:27], v[192:207]
    s_cmp_lg_u32 s63, 0
    s_cbranch_scc1 gated_mix__softmax_full_mha__sliding_block__prompt_kernel_v_fa_18
    s_getreg_b32 s45, hwreg(HW_REG_IB_STS)
    s_and_b32 s45, s45, 0x00c0000f
    s_cbranch_scc1 gated_mix__softmax_full_mha__sliding_block__prompt_kernel_v_fa_18
    s_mov_b64 exec, 1
    buffer_store_dwordx2 v[172:173], v174, s[28:31], s62 offen sc1
    s_mov_b64 exec, -1
    s_mov_b32 s63, 1
gated_mix__softmax_full_mha__sliding_block__prompt_kernel_v_fa_18:
    v_mfma_f32_32x32x16_bf16 v[208:223], v[48:51], v[60:63], v[208:223]
    ds_read_b128 v[96:99], v11 offset:16384
    ds_read_b64_tr_b16 v[108:109], v16 offset:55296
    ds_read_b64_tr_b16 v[110:111], v16 offset:55808
    v_mfma_f32_32x32x16_bf16 v[224:239], v[48:51], v[64:67], v[224:239]
    ds_read_b64_tr_b16 v[112:113], v17 offset:55296
    ds_read_b64_tr_b16 v[114:115], v17 offset:55808
    s_waitcnt lgkmcnt(5)
    ds_read_b64_tr_b16 v[100:101], v18 offset:52224
    v_mfma_f32_32x32x16_bf16 v[176:191], v[52:55], v[48:51], v[176:191]
    ds_read_b64_tr_b16 v[102:103], v18 offset:52480
    ds_read_b64_tr_b16 v[104:105], v18 offset:56320
    ds_read_b64_tr_b16 v[106:107], v18 offset:56576
    v_mfma_f32_32x32x16_bf16 v[192:207], v[56:59], v[48:51], v[192:207]
    s_waitcnt lgkmcnt(0)
    s_barrier
    v_mfma_f32_32x32x16_bf16 v[208:223], v[72:75], v[84:87], v[208:223]
    ds_read_b128 v[24:27], v8 offset:32768
    ds_read_b64_tr_b16 v[36:37], v16 offset:0
    ds_read_b64_tr_b16 v[38:39], v16 offset:512
    v_mfma_f32_32x32x16_bf16 v[224:239], v[72:75], v[88:91], v[224:239]
    ds_read_b64_tr_b16 v[40:41], v17 offset:0
    ds_read_b64_tr_b16 v[42:43], v17 offset:512
    ds_read_b64_tr_b16 v[28:29], v18 offset:0
    v_mfma_f32_32x32x16_bf16 v[176:191], v[76:79], v[72:75], v[176:191]
    ds_read_b64_tr_b16 v[30:31], v18 offset:256
    ds_read_b64_tr_b16 v[32:33], v18 offset:4096
    ds_read_b64_tr_b16 v[34:35], v18 offset:4352
    v_mfma_f32_32x32x16_bf16 v[192:207], v[80:83], v[72:75], v[192:207]
    s_cmp_lg_u32 s63, 0
    s_cbranch_scc1 gated_mix__softmax_full_mha__sliding_block__prompt_kernel_v_fa_19
    s_getreg_b32 s45, hwreg(HW_REG_IB_STS)
    s_and_b32 s45, s45, 0x00c0000f
    s_cbranch_scc1 gated_mix__softmax_full_mha__sliding_block__prompt_kernel_v_fa_19
    s_mov_b64 exec, 1
    buffer_store_dwordx2 v[172:173], v174, s[28:31], s62 offen sc1
    s_mov_b64 exec, -1
    s_mov_b32 s63, 1
gated_mix__softmax_full_mha__sliding_block__prompt_kernel_v_fa_19:
    v_mfma_f32_32x32x16_bf16 v[208:223], v[96:99], v[108:111], v[208:223]
    ds_read_b128 v[48:51], v9 offset:32768
    ds_read_b64_tr_b16 v[60:61], v16 offset:2048
    ds_read_b64_tr_b16 v[62:63], v16 offset:2560
    v_mfma_f32_32x32x16_bf16 v[224:239], v[96:99], v[112:115], v[224:239]
    ds_read_b64_tr_b16 v[64:65], v17 offset:2048
    ds_read_b64_tr_b16 v[66:67], v17 offset:2560
    s_waitcnt lgkmcnt(5)
    ds_read_b64_tr_b16 v[52:53], v18 offset:1024
    v_mfma_f32_32x32x16_bf16 v[176:191], v[100:103], v[96:99], v[176:191]
    ds_read_b64_tr_b16 v[54:55], v18 offset:1280
    ds_read_b64_tr_b16 v[56:57], v18 offset:5120
    ds_read_b64_tr_b16 v[58:59], v18 offset:5376
    v_mfma_f32_32x32x16_bf16 v[192:207], v[104:107], v[96:99], v[192:207]
    v_mfma_f32_32x32x16_bf16 v[208:223], v[24:27], v[36:39], v[208:223]
    ds_read_b128 v[72:75], v10 offset:32768
    ds_read_b64_tr_b16 v[84:85], v16 offset:4096
    ds_read_b64_tr_b16 v[86:87], v16 offset:4608
    v_mfma_f32_32x32x16_bf16 v[224:239], v[24:27], v[40:43], v[224:239]
    ds_read_b64_tr_b16 v[88:89], v17 offset:4096
    ds_read_b64_tr_b16 v[90:91], v17 offset:4608
    s_waitcnt lgkmcnt(5)
    ds_read_b64_tr_b16 v[76:77], v18 offset:2048
    v_mfma_f32_32x32x16_bf16 v[176:191], v[28:31], v[24:27], v[176:191]
    ds_read_b64_tr_b16 v[78:79], v18 offset:2304
    ds_read_b64_tr_b16 v[80:81], v18 offset:6144
    ds_read_b64_tr_b16 v[82:83], v18 offset:6400
    v_mfma_f32_32x32x16_bf16 v[192:207], v[32:35], v[24:27], v[192:207]
    s_cmp_lg_u32 s63, 0
    s_cbranch_scc1 gated_mix__softmax_full_mha__sliding_block__prompt_kernel_v_fa_20
    s_getreg_b32 s45, hwreg(HW_REG_IB_STS)
    s_and_b32 s45, s45, 0x00c0000f
    s_cbranch_scc1 gated_mix__softmax_full_mha__sliding_block__prompt_kernel_v_fa_20
    s_mov_b64 exec, 1
    buffer_store_dwordx2 v[172:173], v174, s[28:31], s62 offen sc1
    s_mov_b64 exec, -1
    s_mov_b32 s63, 1
gated_mix__softmax_full_mha__sliding_block__prompt_kernel_v_fa_20:
    v_mfma_f32_32x32x16_bf16 v[208:223], v[48:51], v[60:63], v[208:223]
    ds_read_b128 v[96:99], v11 offset:32768
    ds_read_b64_tr_b16 v[108:109], v16 offset:6144
    ds_read_b64_tr_b16 v[110:111], v16 offset:6656
    v_mfma_f32_32x32x16_bf16 v[224:239], v[48:51], v[64:67], v[224:239]
    ds_read_b64_tr_b16 v[112:113], v17 offset:6144
    ds_read_b64_tr_b16 v[114:115], v17 offset:6656
    s_waitcnt lgkmcnt(5)
    ds_read_b64_tr_b16 v[100:101], v18 offset:3072
    v_mfma_f32_32x32x16_bf16 v[176:191], v[52:55], v[48:51], v[176:191]
    ds_read_b64_tr_b16 v[102:103], v18 offset:3328
    ds_read_b64_tr_b16 v[104:105], v18 offset:7168
    ds_read_b64_tr_b16 v[106:107], v18 offset:7424
    v_mfma_f32_32x32x16_bf16 v[192:207], v[56:59], v[48:51], v[192:207]
    s_waitcnt lgkmcnt(0)
    s_barrier
    v_mfma_f32_32x32x16_bf16 v[208:223], v[72:75], v[84:87], v[208:223]
    ds_read_b128 v[24:27], v8 offset:49152
    ds_read_b64_tr_b16 v[36:37], v16 offset:16384
    ds_read_b64_tr_b16 v[38:39], v16 offset:16896
    v_mfma_f32_32x32x16_bf16 v[224:239], v[72:75], v[88:91], v[224:239]
    ds_read_b64_tr_b16 v[40:41], v17 offset:16384
    ds_read_b64_tr_b16 v[42:43], v17 offset:16896
    ds_read_b64_tr_b16 v[28:29], v18 offset:16384
    v_mfma_f32_32x32x16_bf16 v[176:191], v[76:79], v[72:75], v[176:191]
    ds_read_b64_tr_b16 v[30:31], v18 offset:16640
    ds_read_b64_tr_b16 v[32:33], v18 offset:20480
    ds_read_b64_tr_b16 v[34:35], v18 offset:20736
    v_mfma_f32_32x32x16_bf16 v[192:207], v[80:83], v[72:75], v[192:207]
    s_cmp_lg_u32 s63, 0
    s_cbranch_scc1 gated_mix__softmax_full_mha__sliding_block__prompt_kernel_v_fa_21
    s_getreg_b32 s45, hwreg(HW_REG_IB_STS)
    s_and_b32 s45, s45, 0x00c0000f
    s_cbranch_scc1 gated_mix__softmax_full_mha__sliding_block__prompt_kernel_v_fa_21
    s_mov_b64 exec, 1
    buffer_store_dwordx2 v[172:173], v174, s[28:31], s62 offen sc1
    s_mov_b64 exec, -1
    s_mov_b32 s63, 1
gated_mix__softmax_full_mha__sliding_block__prompt_kernel_v_fa_21:
    v_mfma_f32_32x32x16_bf16 v[208:223], v[96:99], v[108:111], v[208:223]
    ds_read_b128 v[48:51], v9 offset:49152
    ds_read_b64_tr_b16 v[60:61], v16 offset:18432
    ds_read_b64_tr_b16 v[62:63], v16 offset:18944
    v_mfma_f32_32x32x16_bf16 v[224:239], v[96:99], v[112:115], v[224:239]
    ds_read_b64_tr_b16 v[64:65], v17 offset:18432
    ds_read_b64_tr_b16 v[66:67], v17 offset:18944
    s_waitcnt lgkmcnt(5)
    ds_read_b64_tr_b16 v[52:53], v18 offset:17408
    v_mfma_f32_32x32x16_bf16 v[176:191], v[100:103], v[96:99], v[176:191]
    ds_read_b64_tr_b16 v[54:55], v18 offset:17664
    ds_read_b64_tr_b16 v[56:57], v18 offset:21504
    ds_read_b64_tr_b16 v[58:59], v18 offset:21760
    v_mfma_f32_32x32x16_bf16 v[192:207], v[104:107], v[96:99], v[192:207]
    v_mfma_f32_32x32x16_bf16 v[208:223], v[24:27], v[36:39], v[208:223]
    ds_read_b128 v[72:75], v10 offset:49152
    ds_read_b64_tr_b16 v[84:85], v16 offset:20480
    ds_read_b64_tr_b16 v[86:87], v16 offset:20992
    v_mfma_f32_32x32x16_bf16 v[224:239], v[24:27], v[40:43], v[224:239]
    ds_read_b64_tr_b16 v[88:89], v17 offset:20480
    ds_read_b64_tr_b16 v[90:91], v17 offset:20992
    s_waitcnt lgkmcnt(5)
    ds_read_b64_tr_b16 v[76:77], v18 offset:18432
    v_mfma_f32_32x32x16_bf16 v[176:191], v[28:31], v[24:27], v[176:191]
    ds_read_b64_tr_b16 v[78:79], v18 offset:18688
    ds_read_b64_tr_b16 v[80:81], v18 offset:22528
    ds_read_b64_tr_b16 v[82:83], v18 offset:22784
    v_mfma_f32_32x32x16_bf16 v[192:207], v[32:35], v[24:27], v[192:207]
    s_cmp_lg_u32 s63, 0
    s_cbranch_scc1 gated_mix__softmax_full_mha__sliding_block__prompt_kernel_v_fa_22
    s_getreg_b32 s45, hwreg(HW_REG_IB_STS)
    s_and_b32 s45, s45, 0x00c0000f
    s_cbranch_scc1 gated_mix__softmax_full_mha__sliding_block__prompt_kernel_v_fa_22
    s_mov_b64 exec, 1
    buffer_store_dwordx2 v[172:173], v174, s[28:31], s62 offen sc1
    s_mov_b64 exec, -1
    s_mov_b32 s63, 1
gated_mix__softmax_full_mha__sliding_block__prompt_kernel_v_fa_22:
    v_mfma_f32_32x32x16_bf16 v[208:223], v[48:51], v[60:63], v[208:223]
    ds_read_b128 v[96:99], v11 offset:49152
    ds_read_b64_tr_b16 v[108:109], v16 offset:22528
    ds_read_b64_tr_b16 v[110:111], v16 offset:23040
    v_mfma_f32_32x32x16_bf16 v[224:239], v[48:51], v[64:67], v[224:239]
    ds_read_b64_tr_b16 v[112:113], v17 offset:22528
    ds_read_b64_tr_b16 v[114:115], v17 offset:23040
    s_waitcnt lgkmcnt(5)
    ds_read_b64_tr_b16 v[100:101], v18 offset:19456
    v_mfma_f32_32x32x16_bf16 v[176:191], v[52:55], v[48:51], v[176:191]
    ds_read_b64_tr_b16 v[102:103], v18 offset:19712
    ds_read_b64_tr_b16 v[104:105], v18 offset:23552
    ds_read_b64_tr_b16 v[106:107], v18 offset:23808
    v_mfma_f32_32x32x16_bf16 v[192:207], v[56:59], v[48:51], v[192:207]
    s_waitcnt lgkmcnt(0)
    s_barrier
    v_mfma_f32_32x32x16_bf16 v[208:223], v[72:75], v[84:87], v[208:223]
    ds_read_b128 v[24:27], v12 offset:0
    ds_read_b64_tr_b16 v[36:37], v16 offset:32768
    ds_read_b64_tr_b16 v[38:39], v16 offset:33280
    v_mfma_f32_32x32x16_bf16 v[224:239], v[72:75], v[88:91], v[224:239]
    ds_read_b64_tr_b16 v[40:41], v17 offset:32768
    ds_read_b64_tr_b16 v[42:43], v17 offset:33280
    ds_read_b64_tr_b16 v[28:29], v18 offset:32768
    v_mfma_f32_32x32x16_bf16 v[176:191], v[76:79], v[72:75], v[176:191]
    ds_read_b64_tr_b16 v[30:31], v18 offset:33024
    ds_read_b64_tr_b16 v[32:33], v18 offset:36864
    ds_read_b64_tr_b16 v[34:35], v18 offset:37120
    v_mfma_f32_32x32x16_bf16 v[192:207], v[80:83], v[72:75], v[192:207]
    s_cmp_lg_u32 s63, 0
    s_cbranch_scc1 gated_mix__softmax_full_mha__sliding_block__prompt_kernel_v_fa_23
    s_getreg_b32 s45, hwreg(HW_REG_IB_STS)
    s_and_b32 s45, s45, 0x00c0000f
    s_cbranch_scc1 gated_mix__softmax_full_mha__sliding_block__prompt_kernel_v_fa_23
    s_mov_b64 exec, 1
    buffer_store_dwordx2 v[172:173], v174, s[28:31], s62 offen sc1
    s_mov_b64 exec, -1
    s_mov_b32 s63, 1
gated_mix__softmax_full_mha__sliding_block__prompt_kernel_v_fa_23:
    v_mfma_f32_32x32x16_bf16 v[208:223], v[96:99], v[108:111], v[208:223]
    ds_read_b128 v[48:51], v13 offset:0
    ds_read_b64_tr_b16 v[60:61], v16 offset:34816
    ds_read_b64_tr_b16 v[62:63], v16 offset:35328
    v_mfma_f32_32x32x16_bf16 v[224:239], v[96:99], v[112:115], v[224:239]
    ds_read_b64_tr_b16 v[64:65], v17 offset:34816
    ds_read_b64_tr_b16 v[66:67], v17 offset:35328
    s_waitcnt lgkmcnt(5)
    ds_read_b64_tr_b16 v[52:53], v18 offset:33792
    v_mfma_f32_32x32x16_bf16 v[176:191], v[100:103], v[96:99], v[176:191]
    ds_read_b64_tr_b16 v[54:55], v18 offset:34048
    ds_read_b64_tr_b16 v[56:57], v18 offset:37888
    ds_read_b64_tr_b16 v[58:59], v18 offset:38144
    v_mfma_f32_32x32x16_bf16 v[192:207], v[104:107], v[96:99], v[192:207]
    v_mfma_f32_32x32x16_bf16 v[208:223], v[24:27], v[36:39], v[208:223]
    ds_read_b128 v[72:75], v14 offset:0
    ds_read_b64_tr_b16 v[84:85], v16 offset:36864
    ds_read_b64_tr_b16 v[86:87], v16 offset:37376
    v_mfma_f32_32x32x16_bf16 v[224:239], v[24:27], v[40:43], v[224:239]
    ds_read_b64_tr_b16 v[88:89], v17 offset:36864
    ds_read_b64_tr_b16 v[90:91], v17 offset:37376
    s_waitcnt lgkmcnt(5)
    ds_read_b64_tr_b16 v[76:77], v18 offset:34816
    v_mfma_f32_32x32x16_bf16 v[176:191], v[28:31], v[24:27], v[176:191]
    ds_read_b64_tr_b16 v[78:79], v18 offset:35072
    ds_read_b64_tr_b16 v[80:81], v18 offset:38912
    ds_read_b64_tr_b16 v[82:83], v18 offset:39168
    v_mfma_f32_32x32x16_bf16 v[192:207], v[32:35], v[24:27], v[192:207]
    s_cmp_lg_u32 s63, 0
    s_cbranch_scc1 gated_mix__softmax_full_mha__sliding_block__prompt_kernel_v_fa_24
    s_getreg_b32 s45, hwreg(HW_REG_IB_STS)
    s_and_b32 s45, s45, 0x00c0000f
    s_cbranch_scc1 gated_mix__softmax_full_mha__sliding_block__prompt_kernel_v_fa_24
    s_mov_b64 exec, 1
    buffer_store_dwordx2 v[172:173], v174, s[28:31], s62 offen sc1
    s_mov_b64 exec, -1
    s_mov_b32 s63, 1
gated_mix__softmax_full_mha__sliding_block__prompt_kernel_v_fa_24:
    v_mfma_f32_32x32x16_bf16 v[208:223], v[48:51], v[60:63], v[208:223]
    ds_read_b128 v[96:99], v15 offset:0
    ds_read_b64_tr_b16 v[108:109], v16 offset:38912
    ds_read_b64_tr_b16 v[110:111], v16 offset:39424
    v_mfma_f32_32x32x16_bf16 v[224:239], v[48:51], v[64:67], v[224:239]
    ds_read_b64_tr_b16 v[112:113], v17 offset:38912
    ds_read_b64_tr_b16 v[114:115], v17 offset:39424
    s_waitcnt lgkmcnt(5)
    ds_read_b64_tr_b16 v[100:101], v18 offset:35840
    v_mfma_f32_32x32x16_bf16 v[176:191], v[52:55], v[48:51], v[176:191]
    ds_read_b64_tr_b16 v[102:103], v18 offset:36096
    ds_read_b64_tr_b16 v[104:105], v18 offset:39936
    ds_read_b64_tr_b16 v[106:107], v18 offset:40192
    v_mfma_f32_32x32x16_bf16 v[192:207], v[56:59], v[48:51], v[192:207]
    s_waitcnt lgkmcnt(0)
    s_barrier
    v_mfma_f32_32x32x16_bf16 v[208:223], v[72:75], v[84:87], v[208:223]
    ds_read_b128 v[24:27], v8 offset:0
    ds_read_b64_tr_b16 v[36:37], v16 offset:49152
    ds_read_b64_tr_b16 v[38:39], v16 offset:49664
    v_mfma_f32_32x32x16_bf16 v[224:239], v[72:75], v[88:91], v[224:239]
    ds_read_b64_tr_b16 v[40:41], v17 offset:49152
    ds_read_b64_tr_b16 v[42:43], v17 offset:49664
    ds_read_b64_tr_b16 v[28:29], v18 offset:49152
    v_mfma_f32_32x32x16_bf16 v[176:191], v[76:79], v[72:75], v[176:191]
    ds_read_b64_tr_b16 v[30:31], v18 offset:49408
    ds_read_b64_tr_b16 v[32:33], v18 offset:53248
    ds_read_b64_tr_b16 v[34:35], v18 offset:53504
    v_mfma_f32_32x32x16_bf16 v[192:207], v[80:83], v[72:75], v[192:207]
    s_cmp_lg_u32 s63, 0
    s_cbranch_scc1 gated_mix__softmax_full_mha__sliding_block__prompt_kernel_v_fa_25
    s_getreg_b32 s45, hwreg(HW_REG_IB_STS)
    s_and_b32 s45, s45, 0x00c0000f
    s_cbranch_scc1 gated_mix__softmax_full_mha__sliding_block__prompt_kernel_v_fa_25
    s_mov_b64 exec, 1
    buffer_store_dwordx2 v[172:173], v174, s[28:31], s62 offen sc1
    s_mov_b64 exec, -1
    s_mov_b32 s63, 1
gated_mix__softmax_full_mha__sliding_block__prompt_kernel_v_fa_25:
    v_mfma_f32_32x32x16_bf16 v[208:223], v[96:99], v[108:111], v[208:223]
    ds_read_b128 v[48:51], v9 offset:0
    ds_read_b64_tr_b16 v[60:61], v16 offset:51200
    ds_read_b64_tr_b16 v[62:63], v16 offset:51712
    v_mfma_f32_32x32x16_bf16 v[224:239], v[96:99], v[112:115], v[224:239]
    ds_read_b64_tr_b16 v[64:65], v17 offset:51200
    ds_read_b64_tr_b16 v[66:67], v17 offset:51712
    s_waitcnt lgkmcnt(5)
    ds_read_b64_tr_b16 v[52:53], v18 offset:50176
    v_mfma_f32_32x32x16_bf16 v[176:191], v[100:103], v[96:99], v[176:191]
    ds_read_b64_tr_b16 v[54:55], v18 offset:50432
    ds_read_b64_tr_b16 v[56:57], v18 offset:54272
    ds_read_b64_tr_b16 v[58:59], v18 offset:54528
    v_mfma_f32_32x32x16_bf16 v[192:207], v[104:107], v[96:99], v[192:207]
    v_mfma_f32_32x32x16_bf16 v[208:223], v[24:27], v[36:39], v[208:223]
    ds_read_b128 v[72:75], v10 offset:0
    ds_read_b64_tr_b16 v[84:85], v16 offset:53248
    ds_read_b64_tr_b16 v[86:87], v16 offset:53760
    v_mfma_f32_32x32x16_bf16 v[224:239], v[24:27], v[40:43], v[224:239]
    ds_read_b64_tr_b16 v[88:89], v17 offset:53248
    ds_read_b64_tr_b16 v[90:91], v17 offset:53760
    s_waitcnt lgkmcnt(5)
    ds_read_b64_tr_b16 v[76:77], v18 offset:51200
    v_mfma_f32_32x32x16_bf16 v[176:191], v[28:31], v[24:27], v[176:191]
    ds_read_b64_tr_b16 v[78:79], v18 offset:51456
    ds_read_b64_tr_b16 v[80:81], v18 offset:55296
    ds_read_b64_tr_b16 v[82:83], v18 offset:55552
    v_mfma_f32_32x32x16_bf16 v[192:207], v[32:35], v[24:27], v[192:207]
    s_cmp_lg_u32 s63, 0
    s_cbranch_scc1 gated_mix__softmax_full_mha__sliding_block__prompt_kernel_v_fa_26
    s_getreg_b32 s45, hwreg(HW_REG_IB_STS)
    s_and_b32 s45, s45, 0x00c0000f
    s_cbranch_scc1 gated_mix__softmax_full_mha__sliding_block__prompt_kernel_v_fa_26
    s_mov_b64 exec, 1
    buffer_store_dwordx2 v[172:173], v174, s[28:31], s62 offen sc1
    s_mov_b64 exec, -1
    s_mov_b32 s63, 1
gated_mix__softmax_full_mha__sliding_block__prompt_kernel_v_fa_26:
    v_mfma_f32_32x32x16_bf16 v[208:223], v[48:51], v[60:63], v[208:223]
    ds_read_b128 v[96:99], v11 offset:0
    ds_read_b64_tr_b16 v[108:109], v16 offset:55296
    ds_read_b64_tr_b16 v[110:111], v16 offset:55808
    v_mfma_f32_32x32x16_bf16 v[224:239], v[48:51], v[64:67], v[224:239]
    ds_read_b64_tr_b16 v[112:113], v17 offset:55296
    ds_read_b64_tr_b16 v[114:115], v17 offset:55808
    s_waitcnt lgkmcnt(5)
    ds_read_b64_tr_b16 v[100:101], v18 offset:52224
    v_mfma_f32_32x32x16_bf16 v[176:191], v[52:55], v[48:51], v[176:191]
    ds_read_b64_tr_b16 v[102:103], v18 offset:52480
    ds_read_b64_tr_b16 v[104:105], v18 offset:56320
    ds_read_b64_tr_b16 v[106:107], v18 offset:56576
    v_mfma_f32_32x32x16_bf16 v[192:207], v[56:59], v[48:51], v[192:207]
    v_mfma_f32_32x32x16_bf16 v[208:223], v[72:75], v[84:87], v[208:223]
    v_mfma_f32_32x32x16_bf16 v[224:239], v[72:75], v[88:91], v[224:239]
    v_mfma_f32_32x32x16_bf16 v[176:191], v[76:79], v[72:75], v[176:191]
    v_mfma_f32_32x32x16_bf16 v[192:207], v[80:83], v[72:75], v[192:207]
    s_cmp_lg_u32 s63, 0
    s_cbranch_scc1 gated_mix__softmax_full_mha__sliding_block__prompt_kernel_v_fa_27
    s_getreg_b32 s45, hwreg(HW_REG_IB_STS)
    s_and_b32 s45, s45, 0x00c0000f
    s_cbranch_scc1 gated_mix__softmax_full_mha__sliding_block__prompt_kernel_v_fa_27
    s_mov_b64 exec, 1
    buffer_store_dwordx2 v[172:173], v174, s[28:31], s62 offen sc1
    s_mov_b64 exec, -1
    s_mov_b32 s63, 1
gated_mix__softmax_full_mha__sliding_block__prompt_kernel_v_fa_27:
    s_waitcnt lgkmcnt(0)
    v_mfma_f32_32x32x16_bf16 v[208:223], v[96:99], v[108:111], v[208:223]
    v_mfma_f32_32x32x16_bf16 v[224:239], v[96:99], v[112:115], v[224:239]
    v_mfma_f32_32x32x16_bf16 v[176:191], v[100:103], v[96:99], v[176:191]
    v_mfma_f32_32x32x16_bf16 v[192:207], v[104:107], v[96:99], v[192:207]
    s_cmp_lg_u32 s63, 0
    s_cbranch_scc1 gated_mix__softmax_full_mha__sliding_block__prompt_kernel_v_fa_28
    s_waitcnt vmcnt(0)
    s_mov_b64 exec, 1
    buffer_store_dwordx2 v[172:173], v174, s[28:31], s62 offen sc1
    s_mov_b64 exec, -1
gated_mix__softmax_full_mha__sliding_block__prompt_kernel_v_fa_28:
    s_barrier
    v_mad_u32_u24 v152, s52, v153, v156
    buffer_load_dwordx4 v[24:27], v157, s[28:31], s52 offen sc1
    buffer_load_dwordx4 v[40:43], v152, s[28:31], 0 offen offset:0 sc1
    buffer_load_dwordx4 v[44:47], v152, s[28:31], 0 offen offset:512 sc1
    s_add_u32 s52, s52, 2048
    s_cmp_eq_u32 s52, s69
    s_cselect_b32 s52, s68, s52
    v_mad_u32_u24 v152, s52, v153, v156
    buffer_load_dwordx4 v[28:31], v157, s[28:31], s52 offen sc1
    buffer_load_dwordx4 v[48:51], v152, s[28:31], 0 offen offset:0 sc1
    buffer_load_dwordx4 v[52:55], v152, s[28:31], 0 offen offset:512 sc1
    s_mov_b32 s48, 0x3eb8aa3b
    s_mov_b32 s49, 0x3eb8aa3b
    s_lshl_b32 s45, s40, 10
    v_pk_mul_f32 v[176:177], v[176:177], s[48:49]
    v_pk_mul_f32 v[178:179], v[178:179], s[48:49]
    v_pk_mul_f32 v[180:181], v[180:181], s[48:49]
    v_pk_mul_f32 v[182:183], v[182:183], s[48:49]
    v_pk_mul_f32 v[184:185], v[184:185], s[48:49]
    v_pk_mul_f32 v[186:187], v[186:187], s[48:49]
    v_pk_mul_f32 v[188:189], v[188:189], s[48:49]
    v_pk_mul_f32 v[190:191], v[190:191], s[48:49]
    v_cvt_pk_bf16_f32 v176, v176, v177
    v_cvt_pk_bf16_f32 v177, v178, v179
    v_cvt_pk_bf16_f32 v178, v180, v181
    v_cvt_pk_bf16_f32 v179, v182, v183
    v_cvt_pk_bf16_f32 v180, v184, v185
    v_cvt_pk_bf16_f32 v181, v186, v187
    v_cvt_pk_bf16_f32 v182, v188, v189
    v_cvt_pk_bf16_f32 v183, v190, v191
    s_add_u32 s46, s45, 147456
    v_add_u32 v4, s46, v157
    ds_write_b128 v4, v[176:179]
    ds_write_b128 v4, v[180:183] offset:4096
    v_pk_mul_f32 v[192:193], v[192:193], s[48:49]
    v_pk_mul_f32 v[194:195], v[194:195], s[48:49]
    v_pk_mul_f32 v[196:197], v[196:197], s[48:49]
    v_pk_mul_f32 v[198:199], v[198:199], s[48:49]
    v_pk_mul_f32 v[200:201], v[200:201], s[48:49]
    v_pk_mul_f32 v[202:203], v[202:203], s[48:49]
    v_pk_mul_f32 v[204:205], v[204:205], s[48:49]
    v_pk_mul_f32 v[206:207], v[206:207], s[48:49]
    v_cvt_pk_bf16_f32 v192, v192, v193
    v_cvt_pk_bf16_f32 v193, v194, v195
    v_cvt_pk_bf16_f32 v194, v196, v197
    v_cvt_pk_bf16_f32 v195, v198, v199
    v_cvt_pk_bf16_f32 v196, v200, v201
    v_cvt_pk_bf16_f32 v197, v202, v203
    v_cvt_pk_bf16_f32 v198, v204, v205
    v_cvt_pk_bf16_f32 v199, v206, v207
    s_add_u32 s46, s45, 155648
    v_add_u32 v4, s46, v157
    ds_write_b128 v4, v[192:195]
    ds_write_b128 v4, v[196:199] offset:4096
    v_cvt_pk_bf16_f32 v8, v208, v209
    v_cvt_pk_bf16_f32 v9, v210, v211
    v_cvt_pk_bf16_f32 v10, v212, v213
    v_cvt_pk_bf16_f32 v11, v214, v215
    v_cvt_pk_bf16_f32 v12, v216, v217
    v_cvt_pk_bf16_f32 v13, v218, v219
    v_cvt_pk_bf16_f32 v14, v220, v221
    v_cvt_pk_bf16_f32 v15, v222, v223
    v_cvt_pk_bf16_f32 v16, v224, v225
    v_cvt_pk_bf16_f32 v17, v226, v227
    v_cvt_pk_bf16_f32 v18, v228, v229
    v_cvt_pk_bf16_f32 v19, v230, v231
    v_cvt_pk_bf16_f32 v20, v232, v233
    v_cvt_pk_bf16_f32 v21, v234, v235
    v_cvt_pk_bf16_f32 v22, v236, v237
    v_cvt_pk_bf16_f32 v23, v238, v239
    s_add_u32 s70, s70, 4194304
    s_add_u32 s71, s71, 4194304
    s_add_u32 s64, s64, 4194304
    s_add_u32 s65, s65, 4194304
    s_lshl_b32 s45, s40, 7
    s_add_u32 s45, s45, 104448
    v_and_b32 v5, 31, v1
    v_lshlrev_b32 v5, 2, v5
    v_add_u32 v5, s45, v5
    ds_write_b32 v5, v241
    s_branch gated_mix__softmax_full_mha__sliding_block__prompt_kernel_attn
gated_mix__softmax_full_mha__sliding_block__prompt_kernel_loader:
    s_sub_u32 s50, s40, 4
    v_lshrrev_b32 v2, 3, v1
    v_and_b32 v3, 7, v1
    v_lshrrev_b32 v4, 1, v2
    v_xor_b32 v5, v3, v4
    s_lshl_b32 s52, s42, 7
    s_lshl_b32 s53, s50, 5
    s_add_u32 s52, s52, s53
    v_add_u32 v6, s52, v2
    v_lshlrev_b32 v6, 10, v6
    v_lshl_add_u32 v8, v5, 4, v6
    v_add_u32 v9, 0x2000, v8
    v_xor_b32 v9, 64, v9
    v_add_u32 v10, 0x4000, v8
    v_add_u32 v11, 0x4000, v9
    v_and_b32 v5, 1, v4
    v_lshlrev_b32 v5, 2, v5
    v_xor_b32 v5, v3, v5
    s_lshl_b32 s53, s50, 4
    v_add_u32 v6, s53, v2
    v_mul_u32_u24 v6, 3072, v6
    v_lshl_add_u32 v6, v5, 4, v6
    s_and_b32 s45, s41, 1
    s_add_u32 s45, s45, 1
    s_lshl_b32 s45, s45, 10
    s_lshr_b32 s46, s41, 1
    s_lshl_b32 s46, s46, 7
    s_add_u32 s45, s45, s46
    v_add_u32 v12, s45, v6
    v_lshrrev_b32 v5, 2, v1
    v_add_u32 v5, s53, v5
    v_mul_u32_u24 v5, 3072, v5
    v_and_b32 v6, 3, v1
    v_lshl_add_u32 v5, v6, 4, v5
    s_lshl_b32 s45, s41, 6
    v_add_u32 v13, s45, v5
    s_lshl_b32 s54, s50, 12
    s_lshl_b32 s55, s50, 11
    s_add_u32 s55, s55, 90112
    s_lshl_b32 s51, s50, 10
    s_add_u32 s51, s51, 81920
    s_add_u32 s57, s67, 0
    s_and_b32 s57, s57, 7
    s_lshl_b32 s56, s57, 7
    s_add_u32 m0, s54, 0
    s_nop 0
    buffer_load_dwordx4 v8, s[20:23], s56 offen lds
    s_add_u32 m0, s54, 1024
    s_nop 0
    buffer_load_dwordx4 v9, s[20:23], s56 offen lds
    s_add_u32 m0, s54, 2048
    s_nop 0
    buffer_load_dwordx4 v10, s[20:23], s56 offen lds
    s_add_u32 m0, s54, 3072
    s_nop 0
    buffer_load_dwordx4 v11, s[20:23], s56 offen lds
    s_add_u32 s57, s67, 0
    s_and_b32 s57, s57, 7
    s_mul_i32 s57, s57, 196608
    s_add_u32 m0, s55, 0
    s_nop 0
    buffer_load_dwordx4 v12, s[24:27], s57 offen lds
    s_add_u32 m0, s55, 1024
    s_add_u32 s57, s57, 24576
    buffer_load_dwordx4 v12, s[24:27], s57 offen lds
    s_mov_b32 s36, s16
    s_and_b32 s37, s17, 0xffff
    s_mov_b32 s38, 1024
    s_mov_b32 s39, 0x20000
    v_lshlrev_b32 v14, 4, v1
    s_and_b32 s45, s50, 1
    s_lshl_b32 s45, s45, 10
    s_add_u32 m0, s45, 161792
    s_nop 0
    buffer_load_dwordx4 v14, s[36:39], 0 offen lds
    s_add_u32 s57, s67, 1
    s_and_b32 s57, s57, 7
    s_lshl_b32 s56, s57, 7
    s_add_u32 m0, s54, 16384
    s_nop 0
    buffer_load_dwordx4 v8, s[20:23], s56 offen lds
    s_add_u32 m0, s54, 17408
    s_nop 0
    buffer_load_dwordx4 v9, s[20:23], s56 offen lds
    s_add_u32 m0, s54, 18432
    s_nop 0
    buffer_load_dwordx4 v10, s[20:23], s56 offen lds
    s_add_u32 m0, s54, 19456
    s_nop 0
    buffer_load_dwordx4 v11, s[20:23], s56 offen lds
    s_add_u32 s57, s67, 1
    s_and_b32 s57, s57, 7
    s_mul_i32 s57, s57, 196608
    s_add_u32 m0, s55, 16384
    s_nop 0
    buffer_load_dwordx4 v12, s[24:27], s57 offen lds
    s_add_u32 m0, s55, 17408
    s_add_u32 s57, s57, 24576
    buffer_load_dwordx4 v12, s[24:27], s57 offen lds
    s_mov_b32 s28, s10
    s_and_b32 s29, s11, 0xffff
    s_mov_b32 s30, 19922944
    s_mov_b32 s31, 0x20000
    v_mov_b32 v174, 0
    v_lshlrev_b32 v157, 4, v1
    v_lshlrev_b32 v175, 7, v1
    s_mov_b32 s45, 18087936
    buffer_load_dwordx2 v[172:173], v174, s[28:31], s45 offen sc1
    s_add_u32 s57, s67, 2
    s_and_b32 s57, s57, 7
    s_lshl_b32 s56, s57, 7
    s_add_u32 m0, s54, 32768
    s_nop 0
    buffer_load_dwordx4 v8, s[20:23], s56 offen lds
    s_add_u32 m0, s54, 33792
    s_nop 0
    buffer_load_dwordx4 v9, s[20:23], s56 offen lds
    s_add_u32 m0, s54, 34816
    s_nop 0
    buffer_load_dwordx4 v10, s[20:23], s56 offen lds
    s_add_u32 m0, s54, 35840
    s_nop 0
    buffer_load_dwordx4 v11, s[20:23], s56 offen lds
    s_add_u32 s57, s67, 2
    s_and_b32 s57, s57, 7
    s_mul_i32 s57, s57, 196608
    s_add_u32 m0, s55, 32768
    s_nop 0
    buffer_load_dwordx4 v12, s[24:27], s57 offen lds
    s_add_u32 m0, s55, 33792
    s_add_u32 s57, s57, 24576
    buffer_load_dwordx4 v12, s[24:27], s57 offen lds
    s_waitcnt vmcnt(13)
    s_barrier
    s_add_u32 s57, s67, 3
    s_and_b32 s57, s57, 7
    s_lshl_b32 s56, s57, 7
    s_add_u32 m0, s54, 49152
    s_nop 0
    buffer_load_dwordx4 v8, s[20:23], s56 offen lds
    s_add_u32 m0, s54, 50176
    s_nop 0
    buffer_load_dwordx4 v9, s[20:23], s56 offen lds
    s_add_u32 m0, s54, 51200
    s_nop 0
    buffer_load_dwordx4 v10, s[20:23], s56 offen lds
    s_add_u32 m0, s54, 52224
    s_nop 0
    buffer_load_dwordx4 v11, s[20:23], s56 offen lds
    s_add_u32 s57, s67, 3
    s_and_b32 s57, s57, 7
    s_mul_i32 s57, s57, 196608
    s_add_u32 m0, s55, 49152
    s_nop 0
    buffer_load_dwordx4 v12, s[24:27], s57 offen lds
    s_add_u32 m0, s55, 50176
    s_add_u32 s57, s57, 24576
    buffer_load_dwordx4 v12, s[24:27], s57 offen lds
    s_add_u32 s57, s67, 4
    s_and_b32 s57, s57, 7
    s_lshl_b32 s56, s57, 7
    s_add_u32 m0, s54, 65536
    s_nop 0
    buffer_load_dwordx4 v8, s[20:23], s56 offen lds
    s_add_u32 m0, s54, 66560
    s_nop 0
    buffer_load_dwordx4 v9, s[20:23], s56 offen lds
    s_add_u32 m0, s54, 67584
    s_nop 0
    buffer_load_dwordx4 v10, s[20:23], s56 offen lds
    s_add_u32 m0, s54, 68608
    s_nop 0
    buffer_load_dwordx4 v11, s[20:23], s56 offen lds
    s_waitcnt vmcnt(17)
    s_barrier
    s_add_u32 s57, s67, 4
    s_and_b32 s57, s57, 7
    s_mul_i32 s57, s57, 196608
    s_add_u32 m0, s55, 0
    s_nop 0
    buffer_load_dwordx4 v12, s[24:27], s57 offen lds
    s_add_u32 m0, s55, 1024
    s_add_u32 s57, s57, 24576
    buffer_load_dwordx4 v12, s[24:27], s57 offen lds
    s_add_u32 s57, s67, 5
    s_and_b32 s57, s57, 7
    s_lshl_b32 s56, s57, 7
    s_add_u32 m0, s54, 0
    s_nop 0
    buffer_load_dwordx4 v8, s[20:23], s56 offen lds
    s_add_u32 m0, s54, 1024
    s_nop 0
    buffer_load_dwordx4 v9, s[20:23], s56 offen lds
    s_add_u32 m0, s54, 2048
    s_nop 0
    buffer_load_dwordx4 v10, s[20:23], s56 offen lds
    s_add_u32 m0, s54, 3072
    s_nop 0
    buffer_load_dwordx4 v11, s[20:23], s56 offen lds
    s_waitcnt vmcnt(16)
    s_barrier
    v_add_co_u32 v172, vcc, 1, v172
    s_nop 1
    v_addc_co_u32 v173, vcc, 0, v173, vcc
    s_add_u32 s57, s67, 5
    s_and_b32 s57, s57, 7
    s_mul_i32 s57, s57, 196608
    s_add_u32 m0, s55, 16384
    s_nop 0
    buffer_load_dwordx4 v12, s[24:27], s57 offen lds
    s_add_u32 m0, s55, 17408
    s_add_u32 s57, s57, 24576
    buffer_load_dwordx4 v12, s[24:27], s57 offen lds
    s_add_u32 s57, s67, 6
    s_and_b32 s57, s57, 7
    s_lshl_b32 s56, s57, 7
    s_add_u32 m0, s54, 16384
    s_nop 0
    buffer_load_dwordx4 v8, s[20:23], s56 offen lds
    s_add_u32 m0, s54, 17408
    s_nop 0
    buffer_load_dwordx4 v9, s[20:23], s56 offen lds
    s_add_u32 m0, s54, 18432
    s_nop 0
    buffer_load_dwordx4 v10, s[20:23], s56 offen lds
    s_add_u32 m0, s54, 19456
    s_nop 0
    buffer_load_dwordx4 v11, s[20:23], s56 offen lds
    s_waitcnt vmcnt(16)
    s_barrier
    s_add_u32 s57, s67, 6
    s_and_b32 s57, s57, 7
    s_mul_i32 s57, s57, 196608
    s_add_u32 m0, s55, 32768
    s_nop 0
    buffer_load_dwordx4 v12, s[24:27], s57 offen lds
    s_add_u32 m0, s55, 33792
    s_add_u32 s57, s57, 24576
    buffer_load_dwordx4 v12, s[24:27], s57 offen lds
    s_add_u32 s57, s67, 7
    s_and_b32 s57, s57, 7
    s_lshl_b32 s56, s57, 7
    s_add_u32 m0, s54, 32768
    s_nop 0
    buffer_load_dwordx4 v8, s[20:23], s56 offen lds
    s_add_u32 m0, s54, 33792
    s_nop 0
    buffer_load_dwordx4 v9, s[20:23], s56 offen lds
    s_add_u32 m0, s54, 34816
    s_nop 0
    buffer_load_dwordx4 v10, s[20:23], s56 offen lds
    s_add_u32 m0, s54, 35840
    s_nop 0
    buffer_load_dwordx4 v11, s[20:23], s56 offen lds
    s_waitcnt vmcnt(16)
    s_barrier
    s_add_u32 s57, s67, 7
    s_and_b32 s57, s57, 7
    s_mul_i32 s57, s57, 196608
    s_add_u32 m0, s55, 49152
    s_nop 0
    buffer_load_dwordx4 v12, s[24:27], s57 offen lds
    s_add_u32 m0, s55, 50176
    s_add_u32 s57, s57, 24576
    buffer_load_dwordx4 v12, s[24:27], s57 offen lds
    s_waitcnt vmcnt(12)
    s_barrier
    s_add_u32 s57, s67, 3
    s_and_b32 s57, s57, 7
    s_mul_i32 s57, s57, 196608
    s_add_u32 m0, s51, 0
    s_nop 0
    buffer_load_dwordx4 v13, s[24:27], s57 offen lds
    s_add_u32 m0, s51, 4096
    s_nop 0
    buffer_load_dwordx4 v13, s[32:35], s57 offen lds
    s_add_u32 m0, s55, 0
    s_nop 0
    buffer_load_dwordx4 v12, s[32:35], s57 offen lds
    s_add_u32 m0, s55, 1024
    s_add_u32 s57, s57, 24576
    buffer_load_dwordx4 v12, s[32:35], s57 offen lds
    s_waitcnt vmcnt(10)
    s_barrier
    s_add_u32 s57, s67, 4
    s_and_b32 s57, s57, 7
    s_mul_i32 s57, s57, 196608
    s_add_u32 m0, s51, 16384
    s_nop 0
    buffer_load_dwordx4 v13, s[24:27], s57 offen lds
    s_add_u32 m0, s51, 20480
    s_nop 0
    buffer_load_dwordx4 v13, s[32:35], s57 offen lds
    s_add_u32 m0, s55, 16384
    s_nop 0
    buffer_load_dwordx4 v12, s[32:35], s57 offen lds
    s_add_u32 m0, s55, 17408
    s_add_u32 s57, s57, 24576
    buffer_load_dwordx4 v12, s[32:35], s57 offen lds
    s_waitcnt vmcnt(8)
    s_barrier
    s_add_u32 s57, s67, 5
    s_and_b32 s57, s57, 7
    s_mul_i32 s57, s57, 196608
    s_add_u32 m0, s51, 32768
    s_nop 0
    buffer_load_dwordx4 v13, s[24:27], s57 offen lds
    s_add_u32 m0, s51, 36864
    s_nop 0
    buffer_load_dwordx4 v13, s[32:35], s57 offen lds
    s_add_u32 m0, s55, 32768
    s_nop 0
    buffer_load_dwordx4 v12, s[32:35], s57 offen lds
    s_add_u32 m0, s55, 33792
    s_add_u32 s57, s57, 24576
    buffer_load_dwordx4 v12, s[32:35], s57 offen lds
    s_waitcnt vmcnt(8)
    s_barrier
    s_add_u32 s57, s67, 6
    s_and_b32 s57, s57, 7
    s_mul_i32 s57, s57, 196608
    s_add_u32 m0, s51, 49152
    s_nop 0
    buffer_load_dwordx4 v13, s[24:27], s57 offen lds
    s_add_u32 m0, s51, 53248
    s_nop 0
    buffer_load_dwordx4 v13, s[32:35], s57 offen lds
    s_add_u32 m0, s55, 49152
    s_nop 0
    buffer_load_dwordx4 v12, s[32:35], s57 offen lds
    s_add_u32 m0, s55, 50176
    s_add_u32 s57, s57, 24576
    buffer_load_dwordx4 v12, s[32:35], s57 offen lds
    s_waitcnt vmcnt(8)
    s_barrier
    s_add_u32 s57, s67, 7
    s_and_b32 s57, s57, 7
    s_mul_i32 s57, s57, 196608
    s_add_u32 m0, s51, 0
    s_nop 0
    buffer_load_dwordx4 v13, s[24:27], s57 offen lds
    s_add_u32 m0, s51, 4096
    s_nop 0
    buffer_load_dwordx4 v13, s[32:35], s57 offen lds
    s_add_u32 m0, s55, 0
    s_nop 0
    buffer_load_dwordx4 v12, s[32:35], s57 offen lds
    s_add_u32 m0, s55, 1024
    s_add_u32 s57, s57, 24576
    buffer_load_dwordx4 v12, s[32:35], s57 offen lds
    s_waitcnt vmcnt(8)
    s_barrier
    s_add_u32 s57, s67, 0
    s_and_b32 s57, s57, 7
    s_mul_i32 s57, s57, 196608
    s_add_u32 m0, s51, 16384
    s_nop 0
    buffer_load_dwordx4 v13, s[24:27], s57 offen lds
    s_add_u32 m0, s51, 20480
    s_nop 0
    buffer_load_dwordx4 v13, s[32:35], s57 offen lds
    s_add_u32 m0, s55, 16384
    s_nop 0
    buffer_load_dwordx4 v12, s[32:35], s57 offen lds
    s_add_u32 m0, s55, 17408
    s_add_u32 s57, s57, 24576
    buffer_load_dwordx4 v12, s[32:35], s57 offen lds
    s_add_u32 s57, s67, 0
    s_and_b32 s57, s57, 7
    s_lshl_b32 s56, s57, 7
    s_add_u32 m0, s54, 49152
    s_nop 0
    buffer_load_dwordx4 v8, s[20:23], s56 offen lds
    s_add_u32 m0, s54, 50176
    s_nop 0
    buffer_load_dwordx4 v9, s[20:23], s56 offen lds
    s_add_u32 m0, s54, 51200
    s_nop 0
    buffer_load_dwordx4 v10, s[20:23], s56 offen lds
    s_add_u32 m0, s54, 52224
    s_nop 0
    buffer_load_dwordx4 v11, s[20:23], s56 offen lds
    s_waitcnt vmcnt(12)
    s_barrier
    s_add_u32 s57, s67, 1
    s_and_b32 s57, s57, 7
    s_mul_i32 s57, s57, 196608
    s_add_u32 m0, s51, 32768
    s_nop 0
    buffer_load_dwordx4 v13, s[24:27], s57 offen lds
    s_add_u32 m0, s51, 36864
    s_nop 0
    buffer_load_dwordx4 v13, s[32:35], s57 offen lds
    s_add_u32 m0, s55, 32768
    s_nop 0
    buffer_load_dwordx4 v12, s[32:35], s57 offen lds
    s_add_u32 m0, s55, 33792
    s_add_u32 s57, s57, 24576
    buffer_load_dwordx4 v12, s[32:35], s57 offen lds
    s_add_u32 s57, s67, 1
    s_and_b32 s57, s57, 7
    s_lshl_b32 s56, s57, 7
    s_add_u32 m0, s54, 65536
    s_nop 0
    buffer_load_dwordx4 v8, s[20:23], s56 offen lds
    s_add_u32 m0, s54, 66560
    s_nop 0
    buffer_load_dwordx4 v9, s[20:23], s56 offen lds
    s_add_u32 m0, s54, 67584
    s_nop 0
    buffer_load_dwordx4 v10, s[20:23], s56 offen lds
    s_add_u32 m0, s54, 68608
    s_nop 0
    buffer_load_dwordx4 v11, s[20:23], s56 offen lds
    s_waitcnt vmcnt(16)
    s_barrier
    s_add_u32 s57, s67, 2
    s_and_b32 s57, s57, 7
    s_mul_i32 s57, s57, 196608
    s_add_u32 m0, s51, 49152
    s_nop 0
    buffer_load_dwordx4 v13, s[24:27], s57 offen lds
    s_add_u32 m0, s51, 53248
    s_nop 0
    buffer_load_dwordx4 v13, s[32:35], s57 offen lds
    s_add_u32 m0, s55, 49152
    s_nop 0
    buffer_load_dwordx4 v12, s[32:35], s57 offen lds
    s_add_u32 m0, s55, 50176
    s_add_u32 s57, s57, 24576
    buffer_load_dwordx4 v12, s[32:35], s57 offen lds
    s_add_u32 s57, s67, 2
    s_and_b32 s57, s57, 7
    s_lshl_b32 s56, s57, 7
    s_add_u32 m0, s54, 0
    s_nop 0
    buffer_load_dwordx4 v8, s[20:23], s56 offen lds
    s_add_u32 m0, s54, 1024
    s_nop 0
    buffer_load_dwordx4 v9, s[20:23], s56 offen lds
    s_add_u32 m0, s54, 2048
    s_nop 0
    buffer_load_dwordx4 v10, s[20:23], s56 offen lds
    s_add_u32 m0, s54, 3072
    s_nop 0
    buffer_load_dwordx4 v11, s[20:23], s56 offen lds
    s_and_b32 s51, s40, 3
    v_lshrrev_b32 v3, 5, v1
    v_and_b32 v4, 15, v1
    v_lshlrev_b32 v4, 4, v4
    v_lshl_add_u32 v5, v3, 8, v4
    v_add_u32 v5, 1024, v5
    s_lshl_b32 s45, s2, 10
    s_add_u32 s45, s45, 18350080
    v_add_u32 v4, s45, v4
    v_bfe_u32 v6, v1, 4, 1
    v_xor_b32 v153, 1, v6
    v_mul_u32_u24 v5, v5, v153
    v_sub_u32 v6, 0, v6
    v_and_b32 v4, v4, v6
    v_add_u32 v156, v4, v5
    s_lshl_b32 s45, s43, 6
    s_lshl_b32 s46, s51, 4
    s_add_u32 s45, s45, s46
    s_lshl_b32 s45, s45, 11
    s_add_u32 s68, s45, 4194304
    s_add_u32 s69, s68, 32768
    s_and_b32 s45, s42, 7
    s_lshl_b32 s45, s45, 12
    s_add_u32 s52, s68, s45
    v_and_b32 v2, 31, v1
    v_lshrrev_b32 v7, 5, v1
    s_mul_i32 s45, s44, 12
    s_add_u32 s45, s45, s51
    s_lshl_b32 s45, s45, 11
    v_add_u32 v158, s45, v157
    v_and_b32 v4, 15, v1
    v_lshlrev_b32 v4, 4, v4
    v_lshl_add_u32 v5, v7, 8, v4
    s_add_u32 s45, s45, 17408
    v_add_u32 v5, s45, v5
    v_add_u32 v4, 147456, v4
    v_mul_u32_u24 v5, v5, v153
    v_xor_b32 v6, 1, v153
    v_mul_u32_u24 v4, v4, v6
    v_add_u32 v159, v4, v5
    v_lshlrev_b32 v160, 11, v153
    v_lshlrev_b32 v6, 2, v7
    v_sub_u32 v6, v2, v6
    s_mov_b32 s45, 0xf149f2ca
    v_subrev_u32 v7, 0, v6
    v_ashrrev_i32 v7, 31, v7
    v_and_b32 v240, s45, v7
    v_xor_b32 v224, s45, v240
    v_subrev_u32 v7, 1, v6
    v_ashrrev_i32 v7, 31, v7
    v_and_b32 v241, s45, v7
    v_xor_b32 v225, s45, v241
    v_subrev_u32 v7, 2, v6
    v_ashrrev_i32 v7, 31, v7
    v_and_b32 v242, s45, v7
    v_xor_b32 v226, s45, v242
    v_subrev_u32 v7, 3, v6
    v_ashrrev_i32 v7, 31, v7
    v_and_b32 v243, s45, v7
    v_xor_b32 v227, s45, v243
    v_subrev_u32 v7, 8, v6
    v_ashrrev_i32 v7, 31, v7
    v_and_b32 v244, s45, v7
    v_xor_b32 v228, s45, v244
    v_subrev_u32 v7, 9, v6
    v_ashrrev_i32 v7, 31, v7
    v_and_b32 v245, s45, v7
    v_xor_b32 v229, s45, v245
    v_subrev_u32 v7, 10, v6
    v_ashrrev_i32 v7, 31, v7
    v_and_b32 v246, s45, v7
    v_xor_b32 v230, s45, v246
    v_subrev_u32 v7, 11, v6
    v_ashrrev_i32 v7, 31, v7
    v_and_b32 v247, s45, v7
    v_xor_b32 v231, s45, v247
    v_subrev_u32 v7, 16, v6
    v_ashrrev_i32 v7, 31, v7
    v_and_b32 v248, s45, v7
    v_xor_b32 v232, s45, v248
    v_subrev_u32 v7, 17, v6
    v_ashrrev_i32 v7, 31, v7
    v_and_b32 v249, s45, v7
    v_xor_b32 v233, s45, v249
    v_subrev_u32 v7, 18, v6
    v_ashrrev_i32 v7, 31, v7
    v_and_b32 v250, s45, v7
    v_xor_b32 v234, s45, v250
    v_subrev_u32 v7, 19, v6
    v_ashrrev_i32 v7, 31, v7
    v_and_b32 v251, s45, v7
    v_xor_b32 v235, s45, v251
    v_subrev_u32 v7, 24, v6
    v_ashrrev_i32 v7, 31, v7
    v_and_b32 v252, s45, v7
    v_xor_b32 v236, s45, v252
    v_subrev_u32 v7, 25, v6
    v_ashrrev_i32 v7, 31, v7
    v_and_b32 v253, s45, v7
    v_xor_b32 v237, s45, v253
    v_subrev_u32 v7, 26, v6
    v_ashrrev_i32 v7, 31, v7
    v_and_b32 v254, s45, v7
    v_xor_b32 v238, s45, v254
    v_subrev_u32 v7, 27, v6
    v_ashrrev_i32 v7, 31, v7
    v_and_b32 v255, s45, v7
    v_xor_b32 v239, s45, v255
    s_mov_b32 s4, s8
    s_and_b32 s5, s9, 0xffff
    s_mov_b32 s6, 524288
    s_mov_b32 s7, 0x20000
    s_mov_b32 s12, s14
    s_and_b32 s13, s15, 0xffff
    s_mov_b32 s14, 524288
    s_mov_b32 s15, 0x20000
    v_lshrrev_b32 v6, 3, v1
    v_bfe_u32 v7, v1, 4, 1
    v_lshlrev_b32 v7, 2, v7
    v_and_b32 v154, 7, v1
    v_xor_b32 v154, v154, v7
    v_lshlrev_b32 v154, 4, v154
    v_lshl_add_u32 v154, v6, 10, v154
    s_lshr_b32 s45, s2, 5
    s_lshl_b32 s45, s45, 7
    v_add_u32 v154, s45, v154
    s_waitcnt vmcnt(16)
    s_barrier
    s_waitcnt vmcnt(8)
    s_barrier
    s_waitcnt vmcnt(0)
    s_barrier
    s_cmp_lg_u32 s40, 4
    s_cbranch_scc1 gated_mix__softmax_full_mha__sliding_block__prompt_kernel_nofa
    s_lshr_b32 s59, s41, 1
    s_lshl_b32 s59, s59, 14
    s_add_u32 s59, s59, 18874368
    s_mov_b32 s45, 262144
    s_branch gated_mix__softmax_full_mha__sliding_block__prompt_kernel_fa_poll_29_ld
gated_mix__softmax_full_mha__sliding_block__prompt_kernel_fa_poll_29:
    v_cmp_eq_u32 s[46:47], v172, v168
    v_cmp_eq_u32 vcc, v173, v169
    s_nop 1
    s_and_b64 s[46:47], s[46:47], vcc
    v_cmp_eq_u32 vcc, v172, v170
    s_nop 1
    s_and_b64 s[46:47], s[46:47], vcc
    v_cmp_eq_u32 vcc, v173, v171
    s_nop 1
    s_and_b64 s[46:47], s[46:47], vcc
    s_cmp_eq_u64 s[46:47], exec
    s_cbranch_scc1 gated_mix__softmax_full_mha__sliding_block__prompt_kernel_fa_ok_30
    s_sub_u32 s45, s45, 1
    s_cbranch_scc1 gated_mix__softmax_full_mha__sliding_block__prompt_kernel_fa_ok_30
    s_sleep 3
gated_mix__softmax_full_mha__sliding_block__prompt_kernel_fa_poll_29_ld:
    buffer_load_dwordx2 v[168:169], v175, s[28:31], s59 offen sc1
    s_add_u32 s58, s59, 8192
    buffer_load_dwordx2 v[170:171], v175, s[28:31], s58 offen sc1
    s_waitcnt vmcnt(0)
    s_branch gated_mix__softmax_full_mha__sliding_block__prompt_kernel_fa_poll_29
gated_mix__softmax_full_mha__sliding_block__prompt_kernel_fa_ok_30:
gated_mix__softmax_full_mha__sliding_block__prompt_kernel_nofa:
    v_mov_b32 v167, 0x40000000
    s_mov_b32 s70, 0
    s_mov_b32 s71, 0
    s_mov_b32 s64, 0
    s_mov_b32 s65, 0
    s_barrier
    v_mad_u32_u24 v152, s52, v153, v156
    buffer_load_dwordx4 v[24:27], v157, s[28:31], s52 offen sc1
    buffer_load_dwordx4 v[40:43], v152, s[28:31], 0 offen offset:0 sc1
    buffer_load_dwordx4 v[44:47], v152, s[28:31], 0 offen offset:512 sc1
    s_add_u32 s52, s52, 2048
    s_cmp_eq_u32 s52, s69
    s_cselect_b32 s52, s68, s52
    v_mad_u32_u24 v152, s52, v153, v156
    buffer_load_dwordx4 v[28:31], v157, s[28:31], s52 offen sc1
    buffer_load_dwordx4 v[48:51], v152, s[28:31], 0 offen offset:0 sc1
    buffer_load_dwordx4 v[52:55], v152, s[28:31], 0 offen offset:512 sc1
gated_mix__softmax_full_mha__sliding_block__prompt_kernel_attn:
    s_waitcnt lgkmcnt(0)
    s_barrier
    s_add_u32 s45, s51, 0
    s_and_b32 s45, s45, 3
    s_lshl_b32 s46, s44, 2
    s_add_u32 s45, s45, s46
    s_lshl_b32 s45, s45, 10
    s_add_u32 s45, s45, 147456
    v_add_u32 v4, s45, v157
    ds_read_b128 v[72:75], v4
    s_add_u32 s45, s51, 1
    s_and_b32 s45, s45, 3
    s_lshl_b32 s46, s44, 2
    s_add_u32 s45, s45, s46
    s_lshl_b32 s45, s45, 10
    s_add_u32 s45, s45, 147456
    v_add_u32 v4, s45, v157
    ds_read_b128 v[76:79], v4
    s_add_u32 s45, s51, 2
    s_and_b32 s45, s45, 3
    s_lshl_b32 s46, s44, 2
    s_add_u32 s45, s45, s46
    s_lshl_b32 s45, s45, 10
    s_add_u32 s45, s45, 147456
    v_add_u32 v4, s45, v157
    ds_read_b128 v[80:83], v4
    s_add_u32 s45, s51, 3
    s_and_b32 s45, s45, 3
    s_lshl_b32 s46, s44, 2
    s_add_u32 s45, s45, s46
    s_lshl_b32 s45, s45, 10
    s_add_u32 s45, s45, 147456
    v_add_u32 v4, s45, v157
    ds_read_b128 v[84:87], v4
    v_and_b32 v2, 31, v1
    s_lshl_b32 s45, s51, 7
    s_add_u32 s45, s45, 104448
    v_lshlrev_b32 v4, 2, v2
    v_add_u32 v4, s45, v4
    ds_read_b32 v155, v4
    s_lshl_b32 s45, s42, 2
    s_add_u32 s54, s45, s51
    s_add_u32 s45, s43, 32
    s_lshl_b32 s45, s45, 17
    s_add_u32 s53, s45, 4194304
    s_min_u32 s55, s54, 8
    s_add_u32 s55, s55, 1
    s_lshl_b32 s45, s42, 2
    s_mul_i32 s46, s51, 3
    s_add_u32 s45, s45, s46
    s_sub_u32 s49, s45, 8
    s_mul_i32 s45, s44, 12
    s_add_u32 s45, s45, s46
    s_lshl_b32 s50, s45, 11
    s_add_u32 s52, s52, 2048
    s_cmp_eq_u32 s52, s69
    s_cselect_b32 s52, s68, s52
    v_mad_u32_u24 v152, s52, v153, v156
    buffer_load_dwordx4 v[32:35], v157, s[28:31], s52 offen sc1
    buffer_load_dwordx4 v[56:59], v152, s[28:31], 0 offen offset:0 sc1
    buffer_load_dwordx4 v[60:63], v152, s[28:31], 0 offen offset:512 sc1
    s_waitcnt vmcnt(6) lgkmcnt(0)
    v_mfma_f32_32x32x16_bf16 v[88:103], v[24:27], v[72:75], 0
    s_nop 7
    s_nop 3
    s_setprio 3
    v_mfma_f32_32x32x16_bf16 v[104:119], v[24:27], v[76:79], 0
    v_exp_f32 v88, v88
    v_exp_f32 v89, v89
    v_exp_f32 v90, v90
    v_exp_f32 v91, v91
    v_cvt_pk_bf16_f32 v120, v88, v89
    v_exp_f32 v92, v92
    v_exp_f32 v93, v93
    v_cvt_pk_bf16_f32 v121, v90, v91
    s_add_u32 s52, s52, 2048
    v_exp_f32 v94, v94
    v_exp_f32 v95, v95
    v_cvt_pk_bf16_f32 v122, v92, v93
    v_exp_f32 v96, v96
    v_exp_f32 v97, v97
    v_cvt_pk_bf16_f32 v123, v94, v95
    v_exp_f32 v98, v98
    s_cmp_eq_u32 s52, s69
    s_cselect_b32 s52, s68, s52
    v_exp_f32 v99, v99
    v_cvt_pk_bf16_f32 v124, v96, v97
    v_exp_f32 v100, v100
    v_exp_f32 v101, v101
    v_cvt_pk_bf16_f32 v125, v98, v99
    v_exp_f32 v102, v102
    v_exp_f32 v103, v103
    v_cvt_pk_bf16_f32 v126, v100, v101
    v_cvt_pk_bf16_f32 v127, v102, v103
    v_mfma_f32_32x32x16_bf16 v[88:103], v[24:27], v[80:83], 0
    v_mad_u32_u24 v152, s52, v153, v156
    v_exp_f32 v104, v104
    v_exp_f32 v105, v105
    v_exp_f32 v106, v106
    v_exp_f32 v107, v107
    v_cvt_pk_bf16_f32 v128, v104, v105
    v_exp_f32 v108, v108
    v_exp_f32 v109, v109
    v_cvt_pk_bf16_f32 v129, v106, v107
    v_mfma_f32_32x32x16_bf16 v[136:151], v[40:43], v[120:123], 0
    buffer_load_dwordx4 v[36:39], v157, s[28:31], s52 offen sc1
    v_exp_f32 v110, v110
    v_exp_f32 v111, v111
    v_cvt_pk_bf16_f32 v130, v108, v109
    v_exp_f32 v112, v112
    v_exp_f32 v113, v113
    v_cvt_pk_bf16_f32 v131, v110, v111
    v_exp_f32 v114, v114
    v_mfma_f32_32x32x16_bf16 v[136:151], v[44:47], v[124:127], v[136:151]
    buffer_load_dwordx4 v[64:67], v152, s[28:31], 0 offen offset:0 sc1
    v_exp_f32 v115, v115
    v_cvt_pk_bf16_f32 v132, v112, v113
    v_exp_f32 v116, v116
    v_exp_f32 v117, v117
    v_cvt_pk_bf16_f32 v133, v114, v115
    v_exp_f32 v118, v118
    v_exp_f32 v119, v119
    v_cvt_pk_bf16_f32 v134, v116, v117
    v_cvt_pk_bf16_f32 v135, v118, v119
    v_mfma_f32_32x32x16_bf16 v[104:119], v[24:27], v[84:87], 0
    buffer_load_dwordx4 v[68:71], v152, s[28:31], 0 offen offset:512 sc1
    v_exp_f32 v88, v88
    v_exp_f32 v89, v89
    v_exp_f32 v90, v90
    v_exp_f32 v91, v91
    v_cvt_pk_bf16_f32 v120, v88, v89
    v_exp_f32 v92, v92
    v_exp_f32 v93, v93
    v_cvt_pk_bf16_f32 v121, v90, v91
    v_mfma_f32_32x32x16_bf16 v[176:191], v[40:43], v[128:131], 0
    v_exp_f32 v94, v94
    v_exp_f32 v95, v95
    v_cvt_pk_bf16_f32 v122, v92, v93
    v_exp_f32 v96, v96
    v_exp_f32 v97, v97
    v_cvt_pk_bf16_f32 v123, v94, v95
    v_exp_f32 v98, v98
    v_mfma_f32_32x32x16_bf16 v[176:191], v[44:47], v[132:135], v[176:191]
    s_waitcnt vmcnt(6)
    v_exp_f32 v99, v99
    v_cvt_pk_bf16_f32 v124, v96, v97
    v_exp_f32 v100, v100
    v_exp_f32 v101, v101
    v_cvt_pk_bf16_f32 v125, v98, v99
    v_exp_f32 v102, v102
    v_exp_f32 v103, v103
    v_cvt_pk_bf16_f32 v126, v100, v101
    v_cvt_pk_bf16_f32 v127, v102, v103
    v_mfma_f32_32x32x16_bf16 v[88:103], v[28:31], v[72:75], 0
    v_exp_f32 v104, v104
    v_exp_f32 v105, v105
    v_exp_f32 v106, v106
    v_exp_f32 v107, v107
    v_cvt_pk_bf16_f32 v128, v104, v105
    v_exp_f32 v108, v108
    v_exp_f32 v109, v109
    v_cvt_pk_bf16_f32 v129, v106, v107
    v_mfma_f32_32x32x16_bf16 v[192:207], v[40:43], v[120:123], 0
    buffer_store_dwordx4 v[8:11], v167, s[28:31], s70 offen sc1
    v_exp_f32 v110, v110
    v_exp_f32 v111, v111
    v_cvt_pk_bf16_f32 v130, v108, v109
    v_exp_f32 v112, v112
    v_exp_f32 v113, v113
    v_cvt_pk_bf16_f32 v131, v110, v111
    v_exp_f32 v114, v114
    v_mfma_f32_32x32x16_bf16 v[192:207], v[44:47], v[124:127], v[192:207]
    v_exp_f32 v115, v115
    v_cvt_pk_bf16_f32 v132, v112, v113
    v_exp_f32 v116, v116
    v_exp_f32 v117, v117
    v_cvt_pk_bf16_f32 v133, v114, v115
    v_exp_f32 v118, v118
    v_exp_f32 v119, v119
    v_cvt_pk_bf16_f32 v134, v116, v117
    v_cvt_pk_bf16_f32 v135, v118, v119
    v_mfma_f32_32x32x16_bf16 v[104:119], v[28:31], v[76:79], 0
    v_exp_f32 v88, v88
    v_exp_f32 v89, v89
    v_exp_f32 v90, v90
    v_exp_f32 v91, v91
    v_cvt_pk_bf16_f32 v120, v88, v89
    v_exp_f32 v92, v92
    v_exp_f32 v93, v93
    v_cvt_pk_bf16_f32 v121, v90, v91
    v_mfma_f32_32x32x16_bf16 v[208:223], v[40:43], v[128:131], 0
    s_add_u32 s52, s52, 2048
    v_exp_f32 v94, v94
    v_exp_f32 v95, v95
    v_cvt_pk_bf16_f32 v122, v92, v93
    v_exp_f32 v96, v96
    v_exp_f32 v97, v97
    v_cvt_pk_bf16_f32 v123, v94, v95
    v_exp_f32 v98, v98
    v_mfma_f32_32x32x16_bf16 v[208:223], v[44:47], v[132:135], v[208:223]
    s_cmp_eq_u32 s52, s69
    s_cselect_b32 s52, s68, s52
    v_exp_f32 v99, v99
    v_cvt_pk_bf16_f32 v124, v96, v97
    v_exp_f32 v100, v100
    v_exp_f32 v101, v101
    v_cvt_pk_bf16_f32 v125, v98, v99
    v_exp_f32 v102, v102
    v_exp_f32 v103, v103
    v_cvt_pk_bf16_f32 v126, v100, v101
    v_cvt_pk_bf16_f32 v127, v102, v103
    v_mfma_f32_32x32x16_bf16 v[88:103], v[28:31], v[80:83], 0
    v_mad_u32_u24 v152, s52, v153, v156
    v_exp_f32 v104, v104
    v_exp_f32 v105, v105
    v_exp_f32 v106, v106
    v_exp_f32 v107, v107
    v_cvt_pk_bf16_f32 v128, v104, v105
    v_exp_f32 v108, v108
    v_exp_f32 v109, v109
    v_cvt_pk_bf16_f32 v129, v106, v107
    v_mfma_f32_32x32x16_bf16 v[136:151], v[48:51], v[120:123], v[136:151]
    buffer_load_dwordx4 v[24:27], v157, s[28:31], s52 offen sc1
    v_exp_f32 v110, v110
    v_exp_f32 v111, v111
    v_cvt_pk_bf16_f32 v130, v108, v109
    v_exp_f32 v112, v112
    v_exp_f32 v113, v113
    v_cvt_pk_bf16_f32 v131, v110, v111
    v_exp_f32 v114, v114
    v_mfma_f32_32x32x16_bf16 v[136:151], v[52:55], v[124:127], v[136:151]
    buffer_load_dwordx4 v[40:43], v152, s[28:31], 0 offen offset:0 sc1
    v_exp_f32 v115, v115
    v_cvt_pk_bf16_f32 v132, v112, v113
    v_exp_f32 v116, v116
    v_exp_f32 v117, v117
    v_cvt_pk_bf16_f32 v133, v114, v115
    v_exp_f32 v118, v118
    v_exp_f32 v119, v119
    v_cvt_pk_bf16_f32 v134, v116, v117
    v_cvt_pk_bf16_f32 v135, v118, v119
    v_mfma_f32_32x32x16_bf16 v[104:119], v[28:31], v[84:87], 0
    buffer_load_dwordx4 v[44:47], v152, s[28:31], 0 offen offset:512 sc1
    v_exp_f32 v88, v88
    v_exp_f32 v89, v89
    v_exp_f32 v90, v90
    v_exp_f32 v91, v91
    v_cvt_pk_bf16_f32 v120, v88, v89
    v_exp_f32 v92, v92
    v_exp_f32 v93, v93
    v_cvt_pk_bf16_f32 v121, v90, v91
    v_mfma_f32_32x32x16_bf16 v[176:191], v[48:51], v[128:131], v[176:191]
    v_exp_f32 v94, v94
    v_exp_f32 v95, v95
    v_cvt_pk_bf16_f32 v122, v92, v93
    v_exp_f32 v96, v96
    v_exp_f32 v97, v97
    v_cvt_pk_bf16_f32 v123, v94, v95
    v_exp_f32 v98, v98
    v_mfma_f32_32x32x16_bf16 v[176:191], v[52:55], v[132:135], v[176:191]
    s_waitcnt vmcnt(6)
    v_exp_f32 v99, v99
    v_cvt_pk_bf16_f32 v124, v96, v97
    v_exp_f32 v100, v100
    v_exp_f32 v101, v101
    v_cvt_pk_bf16_f32 v125, v98, v99
    v_exp_f32 v102, v102
    v_exp_f32 v103, v103
    v_cvt_pk_bf16_f32 v126, v100, v101
    v_cvt_pk_bf16_f32 v127, v102, v103
    v_mfma_f32_32x32x16_bf16 v[88:103], v[32:35], v[72:75], 0
    v_exp_f32 v104, v104
    v_exp_f32 v105, v105
    v_exp_f32 v106, v106
    v_exp_f32 v107, v107
    v_cvt_pk_bf16_f32 v128, v104, v105
    v_exp_f32 v108, v108
    v_exp_f32 v109, v109
    v_cvt_pk_bf16_f32 v129, v106, v107
    v_mfma_f32_32x32x16_bf16 v[192:207], v[48:51], v[120:123], v[192:207]
    buffer_store_dwordx4 v[12:15], v167, s[28:31], s71 offen sc1
    v_exp_f32 v110, v110
    v_exp_f32 v111, v111
    v_cvt_pk_bf16_f32 v130, v108, v109
    v_exp_f32 v112, v112
    v_exp_f32 v113, v113
    v_cvt_pk_bf16_f32 v131, v110, v111
    v_exp_f32 v114, v114
    v_mfma_f32_32x32x16_bf16 v[192:207], v[52:55], v[124:127], v[192:207]
    v_exp_f32 v115, v115
    v_cvt_pk_bf16_f32 v132, v112, v113
    v_exp_f32 v116, v116
    v_exp_f32 v117, v117
    v_cvt_pk_bf16_f32 v133, v114, v115
    v_exp_f32 v118, v118
    v_exp_f32 v119, v119
    v_cvt_pk_bf16_f32 v134, v116, v117
    v_cvt_pk_bf16_f32 v135, v118, v119
    v_mfma_f32_32x32x16_bf16 v[104:119], v[32:35], v[76:79], 0
    v_exp_f32 v88, v88
    v_exp_f32 v89, v89
    v_exp_f32 v90, v90
    v_exp_f32 v91, v91
    v_cvt_pk_bf16_f32 v120, v88, v89
    v_exp_f32 v92, v92
    v_exp_f32 v93, v93
    v_cvt_pk_bf16_f32 v121, v90, v91
    v_mfma_f32_32x32x16_bf16 v[208:223], v[48:51], v[128:131], v[208:223]
    s_add_u32 s52, s52, 2048
    v_exp_f32 v94, v94
    v_exp_f32 v95, v95
    v_cvt_pk_bf16_f32 v122, v92, v93
    v_exp_f32 v96, v96
    v_exp_f32 v97, v97
    v_cvt_pk_bf16_f32 v123, v94, v95
    v_exp_f32 v98, v98
    v_mfma_f32_32x32x16_bf16 v[208:223], v[52:55], v[132:135], v[208:223]
    s_cmp_eq_u32 s52, s69
    s_cselect_b32 s52, s68, s52
    v_exp_f32 v99, v99
    v_cvt_pk_bf16_f32 v124, v96, v97
    v_exp_f32 v100, v100
    v_exp_f32 v101, v101
    v_cvt_pk_bf16_f32 v125, v98, v99
    v_exp_f32 v102, v102
    v_exp_f32 v103, v103
    v_cvt_pk_bf16_f32 v126, v100, v101
    v_cvt_pk_bf16_f32 v127, v102, v103
    v_mfma_f32_32x32x16_bf16 v[88:103], v[32:35], v[80:83], 0
    v_mad_u32_u24 v152, s52, v153, v156
    v_exp_f32 v104, v104
    v_exp_f32 v105, v105
    v_exp_f32 v106, v106
    v_exp_f32 v107, v107
    v_cvt_pk_bf16_f32 v128, v104, v105
    v_exp_f32 v108, v108
    v_exp_f32 v109, v109
    v_cvt_pk_bf16_f32 v129, v106, v107
    v_mfma_f32_32x32x16_bf16 v[136:151], v[56:59], v[120:123], v[136:151]
    buffer_load_dwordx4 v[28:31], v157, s[28:31], s52 offen sc1
    v_exp_f32 v110, v110
    v_exp_f32 v111, v111
    v_cvt_pk_bf16_f32 v130, v108, v109
    v_exp_f32 v112, v112
    v_exp_f32 v113, v113
    v_cvt_pk_bf16_f32 v131, v110, v111
    v_exp_f32 v114, v114
    v_mfma_f32_32x32x16_bf16 v[136:151], v[60:63], v[124:127], v[136:151]
    buffer_load_dwordx4 v[48:51], v152, s[28:31], 0 offen offset:0 sc1
    v_exp_f32 v115, v115
    v_cvt_pk_bf16_f32 v132, v112, v113
    v_exp_f32 v116, v116
    v_exp_f32 v117, v117
    v_cvt_pk_bf16_f32 v133, v114, v115
    v_exp_f32 v118, v118
    v_exp_f32 v119, v119
    v_cvt_pk_bf16_f32 v134, v116, v117
    v_cvt_pk_bf16_f32 v135, v118, v119
    v_mfma_f32_32x32x16_bf16 v[104:119], v[32:35], v[84:87], 0
    buffer_load_dwordx4 v[52:55], v152, s[28:31], 0 offen offset:512 sc1
    v_exp_f32 v88, v88
    v_exp_f32 v89, v89
    v_exp_f32 v90, v90
    v_exp_f32 v91, v91
    v_cvt_pk_bf16_f32 v120, v88, v89
    v_exp_f32 v92, v92
    v_exp_f32 v93, v93
    v_cvt_pk_bf16_f32 v121, v90, v91
    v_mfma_f32_32x32x16_bf16 v[176:191], v[56:59], v[128:131], v[176:191]
    v_exp_f32 v94, v94
    v_exp_f32 v95, v95
    v_cvt_pk_bf16_f32 v122, v92, v93
    v_exp_f32 v96, v96
    v_exp_f32 v97, v97
    v_cvt_pk_bf16_f32 v123, v94, v95
    v_exp_f32 v98, v98
    v_mfma_f32_32x32x16_bf16 v[176:191], v[60:63], v[132:135], v[176:191]
    s_waitcnt vmcnt(6)
    v_exp_f32 v99, v99
    v_cvt_pk_bf16_f32 v124, v96, v97
    v_exp_f32 v100, v100
    v_exp_f32 v101, v101
    v_cvt_pk_bf16_f32 v125, v98, v99
    v_exp_f32 v102, v102
    v_exp_f32 v103, v103
    v_cvt_pk_bf16_f32 v126, v100, v101
    v_cvt_pk_bf16_f32 v127, v102, v103
    v_mfma_f32_32x32x16_bf16 v[88:103], v[36:39], v[72:75], 0
    v_exp_f32 v104, v104
    v_exp_f32 v105, v105
    v_exp_f32 v106, v106
    v_exp_f32 v107, v107
    v_cvt_pk_bf16_f32 v128, v104, v105
    v_exp_f32 v108, v108
    v_exp_f32 v109, v109
    v_cvt_pk_bf16_f32 v129, v106, v107
    v_mfma_f32_32x32x16_bf16 v[192:207], v[56:59], v[120:123], v[192:207]
    buffer_store_dwordx4 v[16:19], v167, s[28:31], s64 offen sc1
    v_exp_f32 v110, v110
    v_exp_f32 v111, v111
    v_cvt_pk_bf16_f32 v130, v108, v109
    v_exp_f32 v112, v112
    v_exp_f32 v113, v113
    v_cvt_pk_bf16_f32 v131, v110, v111
    v_exp_f32 v114, v114
    v_mfma_f32_32x32x16_bf16 v[192:207], v[60:63], v[124:127], v[192:207]
    v_exp_f32 v115, v115
    v_cvt_pk_bf16_f32 v132, v112, v113
    v_exp_f32 v116, v116
    v_exp_f32 v117, v117
    v_cvt_pk_bf16_f32 v133, v114, v115
    v_exp_f32 v118, v118
    v_exp_f32 v119, v119
    v_cvt_pk_bf16_f32 v134, v116, v117
    v_cvt_pk_bf16_f32 v135, v118, v119
    v_mfma_f32_32x32x16_bf16 v[104:119], v[36:39], v[76:79], 0
    v_exp_f32 v88, v88
    v_exp_f32 v89, v89
    v_exp_f32 v90, v90
    v_exp_f32 v91, v91
    v_cvt_pk_bf16_f32 v120, v88, v89
    v_exp_f32 v92, v92
    v_exp_f32 v93, v93
    v_cvt_pk_bf16_f32 v121, v90, v91
    v_mfma_f32_32x32x16_bf16 v[208:223], v[56:59], v[128:131], v[208:223]
    s_add_u32 s52, s52, 2048
    v_exp_f32 v94, v94
    v_exp_f32 v95, v95
    v_cvt_pk_bf16_f32 v122, v92, v93
    v_exp_f32 v96, v96
    v_exp_f32 v97, v97
    v_cvt_pk_bf16_f32 v123, v94, v95
    v_exp_f32 v98, v98
    v_mfma_f32_32x32x16_bf16 v[208:223], v[60:63], v[132:135], v[208:223]
    s_cmp_eq_u32 s52, s69
    s_cselect_b32 s52, s68, s52
    v_exp_f32 v99, v99
    v_cvt_pk_bf16_f32 v124, v96, v97
    v_exp_f32 v100, v100
    v_exp_f32 v101, v101
    v_cvt_pk_bf16_f32 v125, v98, v99
    v_exp_f32 v102, v102
    v_exp_f32 v103, v103
    v_cvt_pk_bf16_f32 v126, v100, v101
    v_cvt_pk_bf16_f32 v127, v102, v103
    v_mfma_f32_32x32x16_bf16 v[88:103], v[36:39], v[80:83], 0
    v_mad_u32_u24 v152, s52, v153, v156
    v_exp_f32 v104, v104
    v_exp_f32 v105, v105
    v_exp_f32 v106, v106
    v_exp_f32 v107, v107
    v_cvt_pk_bf16_f32 v128, v104, v105
    v_exp_f32 v108, v108
    v_exp_f32 v109, v109
    v_cvt_pk_bf16_f32 v129, v106, v107
    v_mfma_f32_32x32x16_bf16 v[136:151], v[64:67], v[120:123], v[136:151]
    buffer_load_dwordx4 v[32:35], v157, s[28:31], s52 offen sc1
    v_exp_f32 v110, v110
    v_exp_f32 v111, v111
    v_cvt_pk_bf16_f32 v130, v108, v109
    v_exp_f32 v112, v112
    v_exp_f32 v113, v113
    v_cvt_pk_bf16_f32 v131, v110, v111
    v_exp_f32 v114, v114
    v_mfma_f32_32x32x16_bf16 v[136:151], v[68:71], v[124:127], v[136:151]
    buffer_load_dwordx4 v[56:59], v152, s[28:31], 0 offen offset:0 sc1
    v_exp_f32 v115, v115
    v_cvt_pk_bf16_f32 v132, v112, v113
    v_exp_f32 v116, v116
    v_exp_f32 v117, v117
    v_cvt_pk_bf16_f32 v133, v114, v115
    v_exp_f32 v118, v118
    v_exp_f32 v119, v119
    v_cvt_pk_bf16_f32 v134, v116, v117
    v_cvt_pk_bf16_f32 v135, v118, v119
    v_mfma_f32_32x32x16_bf16 v[104:119], v[36:39], v[84:87], 0
    buffer_load_dwordx4 v[60:63], v152, s[28:31], 0 offen offset:512 sc1
    v_exp_f32 v88, v88
    v_exp_f32 v89, v89
    v_exp_f32 v90, v90
    v_exp_f32 v91, v91
    v_cvt_pk_bf16_f32 v120, v88, v89
    v_exp_f32 v92, v92
    v_exp_f32 v93, v93
    v_cvt_pk_bf16_f32 v121, v90, v91
    v_mfma_f32_32x32x16_bf16 v[176:191], v[64:67], v[128:131], v[176:191]
    v_exp_f32 v94, v94
    v_exp_f32 v95, v95
    v_cvt_pk_bf16_f32 v122, v92, v93
    v_exp_f32 v96, v96
    v_exp_f32 v97, v97
    v_cvt_pk_bf16_f32 v123, v94, v95
    v_exp_f32 v98, v98
    v_mfma_f32_32x32x16_bf16 v[176:191], v[68:71], v[132:135], v[176:191]
    s_waitcnt vmcnt(6)
    v_exp_f32 v99, v99
    v_cvt_pk_bf16_f32 v124, v96, v97
    v_exp_f32 v100, v100
    v_exp_f32 v101, v101
    v_cvt_pk_bf16_f32 v125, v98, v99
    v_exp_f32 v102, v102
    v_exp_f32 v103, v103
    v_cvt_pk_bf16_f32 v126, v100, v101
    v_cvt_pk_bf16_f32 v127, v102, v103
    v_mfma_f32_32x32x16_bf16 v[88:103], v[24:27], v[72:75], 0
    v_exp_f32 v104, v104
    v_exp_f32 v105, v105
    v_exp_f32 v106, v106
    v_exp_f32 v107, v107
    v_cvt_pk_bf16_f32 v128, v104, v105
    v_exp_f32 v108, v108
    v_exp_f32 v109, v109
    v_cvt_pk_bf16_f32 v129, v106, v107
    v_mfma_f32_32x32x16_bf16 v[192:207], v[64:67], v[120:123], v[192:207]
    buffer_store_dwordx4 v[20:23], v167, s[28:31], s65 offen sc1
    v_exp_f32 v110, v110
    v_exp_f32 v111, v111
    v_cvt_pk_bf16_f32 v130, v108, v109
    v_exp_f32 v112, v112
    v_exp_f32 v113, v113
    v_cvt_pk_bf16_f32 v131, v110, v111
    v_exp_f32 v114, v114
    v_mfma_f32_32x32x16_bf16 v[192:207], v[68:71], v[124:127], v[192:207]
    v_exp_f32 v115, v115
    v_cvt_pk_bf16_f32 v132, v112, v113
    v_exp_f32 v116, v116
    v_exp_f32 v117, v117
    v_cvt_pk_bf16_f32 v133, v114, v115
    v_exp_f32 v118, v118
    v_exp_f32 v119, v119
    v_cvt_pk_bf16_f32 v134, v116, v117
    v_cvt_pk_bf16_f32 v135, v118, v119
    s_setprio 2
    s_mov_b32 s56, 0
.p2align 6
gated_mix__softmax_full_mha__sliding_block__prompt_kernel_aloop:
    v_mfma_f32_32x32x16_bf16 v[104:119], v[24:27], v[76:79], 0
    v_exp_f32 v88, v88
    v_exp_f32 v89, v89
    v_exp_f32 v90, v90
    v_exp_f32 v91, v91
    v_cvt_pk_bf16_f32 v120, v88, v89
    v_exp_f32 v92, v92
    v_exp_f32 v93, v93
    v_cvt_pk_bf16_f32 v121, v90, v91
    v_mfma_f32_32x32x16_bf16 v[208:223], v[64:67], v[128:131], v[208:223]
    s_add_u32 s52, s52, 2048
    v_exp_f32 v94, v94
    v_exp_f32 v95, v95
    v_cvt_pk_bf16_f32 v122, v92, v93
    v_exp_f32 v96, v96
    v_exp_f32 v97, v97
    v_cvt_pk_bf16_f32 v123, v94, v95
    v_exp_f32 v98, v98
    v_mfma_f32_32x32x16_bf16 v[208:223], v[68:71], v[132:135], v[208:223]
    s_cmp_eq_u32 s52, s69
    s_cselect_b32 s52, s68, s52
    v_exp_f32 v99, v99
    v_cvt_pk_bf16_f32 v124, v96, v97
    v_exp_f32 v100, v100
    v_exp_f32 v101, v101
    v_cvt_pk_bf16_f32 v125, v98, v99
    v_exp_f32 v102, v102
    v_exp_f32 v103, v103
    v_cvt_pk_bf16_f32 v126, v100, v101
    v_cvt_pk_bf16_f32 v127, v102, v103
    v_mfma_f32_32x32x16_bf16 v[88:103], v[24:27], v[80:83], 0
    v_mad_u32_u24 v152, s52, v153, v156
    v_exp_f32 v104, v104
    v_exp_f32 v105, v105
    v_exp_f32 v106, v106
    v_exp_f32 v107, v107
    v_cvt_pk_bf16_f32 v128, v104, v105
    v_exp_f32 v108, v108
    v_exp_f32 v109, v109
    v_cvt_pk_bf16_f32 v129, v106, v107
    v_mfma_f32_32x32x16_bf16 v[136:151], v[40:43], v[120:123], v[136:151]
    buffer_load_dwordx4 v[36:39], v157, s[28:31], s52 offen sc1
    v_exp_f32 v110, v110
    v_exp_f32 v111, v111
    v_cvt_pk_bf16_f32 v130, v108, v109
    v_exp_f32 v112, v112
    v_exp_f32 v113, v113
    v_cvt_pk_bf16_f32 v131, v110, v111
    v_exp_f32 v114, v114
    v_mfma_f32_32x32x16_bf16 v[136:151], v[44:47], v[124:127], v[136:151]
    buffer_load_dwordx4 v[64:67], v152, s[28:31], 0 offen offset:0 sc1
    v_exp_f32 v115, v115
    v_cvt_pk_bf16_f32 v132, v112, v113
    v_exp_f32 v116, v116
    v_exp_f32 v117, v117
    v_cvt_pk_bf16_f32 v133, v114, v115
    v_exp_f32 v118, v118
    v_exp_f32 v119, v119
    v_cvt_pk_bf16_f32 v134, v116, v117
    v_cvt_pk_bf16_f32 v135, v118, v119
    v_mfma_f32_32x32x16_bf16 v[104:119], v[24:27], v[84:87], 0
    buffer_load_dwordx4 v[68:71], v152, s[28:31], 0 offen offset:512 sc1
    v_exp_f32 v88, v88
    v_exp_f32 v89, v89
    v_exp_f32 v90, v90
    v_exp_f32 v91, v91
    v_cvt_pk_bf16_f32 v120, v88, v89
    v_exp_f32 v92, v92
    v_exp_f32 v93, v93
    v_cvt_pk_bf16_f32 v121, v90, v91
    v_mfma_f32_32x32x16_bf16 v[176:191], v[40:43], v[128:131], v[176:191]
    v_exp_f32 v94, v94
    v_exp_f32 v95, v95
    v_cvt_pk_bf16_f32 v122, v92, v93
    v_exp_f32 v96, v96
    v_exp_f32 v97, v97
    v_cvt_pk_bf16_f32 v123, v94, v95
    v_exp_f32 v98, v98
    v_mfma_f32_32x32x16_bf16 v[176:191], v[44:47], v[132:135], v[176:191]
    s_waitcnt vmcnt(6)
    v_exp_f32 v99, v99
    v_cvt_pk_bf16_f32 v124, v96, v97
    v_exp_f32 v100, v100
    v_exp_f32 v101, v101
    v_cvt_pk_bf16_f32 v125, v98, v99
    v_exp_f32 v102, v102
    v_exp_f32 v103, v103
    v_cvt_pk_bf16_f32 v126, v100, v101
    v_cvt_pk_bf16_f32 v127, v102, v103
    v_mfma_f32_32x32x16_bf16 v[88:103], v[28:31], v[72:75], 0
    v_exp_f32 v104, v104
    v_exp_f32 v105, v105
    v_exp_f32 v106, v106
    v_exp_f32 v107, v107
    v_cvt_pk_bf16_f32 v128, v104, v105
    v_exp_f32 v108, v108
    v_exp_f32 v109, v109
    v_cvt_pk_bf16_f32 v129, v106, v107
    v_mfma_f32_32x32x16_bf16 v[192:207], v[40:43], v[120:123], v[192:207]
    v_exp_f32 v110, v110
    v_exp_f32 v111, v111
    v_cvt_pk_bf16_f32 v130, v108, v109
    v_exp_f32 v112, v112
    v_exp_f32 v113, v113
    v_cvt_pk_bf16_f32 v131, v110, v111
    v_exp_f32 v114, v114
    v_mfma_f32_32x32x16_bf16 v[192:207], v[44:47], v[124:127], v[192:207]
    v_exp_f32 v115, v115
    v_cvt_pk_bf16_f32 v132, v112, v113
    v_exp_f32 v116, v116
    v_exp_f32 v117, v117
    v_cvt_pk_bf16_f32 v133, v114, v115
    v_exp_f32 v118, v118
    v_exp_f32 v119, v119
    v_cvt_pk_bf16_f32 v134, v116, v117
    v_cvt_pk_bf16_f32 v135, v118, v119
    v_mfma_f32_32x32x16_bf16 v[104:119], v[28:31], v[76:79], 0
    v_exp_f32 v88, v88
    v_exp_f32 v89, v89
    v_exp_f32 v90, v90
    v_exp_f32 v91, v91
    v_cvt_pk_bf16_f32 v120, v88, v89
    v_exp_f32 v92, v92
    v_exp_f32 v93, v93
    v_cvt_pk_bf16_f32 v121, v90, v91
    v_mfma_f32_32x32x16_bf16 v[208:223], v[40:43], v[128:131], v[208:223]
    s_add_u32 s52, s52, 2048
    v_exp_f32 v94, v94
    v_exp_f32 v95, v95
    v_cvt_pk_bf16_f32 v122, v92, v93
    v_exp_f32 v96, v96
    v_exp_f32 v97, v97
    v_cvt_pk_bf16_f32 v123, v94, v95
    v_exp_f32 v98, v98
    v_mfma_f32_32x32x16_bf16 v[208:223], v[44:47], v[132:135], v[208:223]
    s_cmp_eq_u32 s52, s69
    s_cselect_b32 s52, s68, s52
    v_exp_f32 v99, v99
    v_cvt_pk_bf16_f32 v124, v96, v97
    v_exp_f32 v100, v100
    v_exp_f32 v101, v101
    v_cvt_pk_bf16_f32 v125, v98, v99
    v_exp_f32 v102, v102
    v_exp_f32 v103, v103
    v_cvt_pk_bf16_f32 v126, v100, v101
    v_cvt_pk_bf16_f32 v127, v102, v103
    v_mfma_f32_32x32x16_bf16 v[88:103], v[28:31], v[80:83], 0
    v_mad_u32_u24 v152, s52, v153, v156
    v_exp_f32 v104, v104
    v_exp_f32 v105, v105
    v_exp_f32 v106, v106
    v_exp_f32 v107, v107
    v_cvt_pk_bf16_f32 v128, v104, v105
    v_exp_f32 v108, v108
    v_exp_f32 v109, v109
    v_cvt_pk_bf16_f32 v129, v106, v107
    v_mfma_f32_32x32x16_bf16 v[136:151], v[48:51], v[120:123], v[136:151]
    buffer_load_dwordx4 v[24:27], v157, s[28:31], s52 offen sc1
    v_exp_f32 v110, v110
    v_exp_f32 v111, v111
    v_cvt_pk_bf16_f32 v130, v108, v109
    v_exp_f32 v112, v112
    v_exp_f32 v113, v113
    v_cvt_pk_bf16_f32 v131, v110, v111
    v_exp_f32 v114, v114
    v_mfma_f32_32x32x16_bf16 v[136:151], v[52:55], v[124:127], v[136:151]
    buffer_load_dwordx4 v[40:43], v152, s[28:31], 0 offen offset:0 sc1
    v_exp_f32 v115, v115
    v_cvt_pk_bf16_f32 v132, v112, v113
    v_exp_f32 v116, v116
    v_exp_f32 v117, v117
    v_cvt_pk_bf16_f32 v133, v114, v115
    v_exp_f32 v118, v118
    v_exp_f32 v119, v119
    v_cvt_pk_bf16_f32 v134, v116, v117
    v_cvt_pk_bf16_f32 v135, v118, v119
    v_mfma_f32_32x32x16_bf16 v[104:119], v[28:31], v[84:87], 0
    buffer_load_dwordx4 v[44:47], v152, s[28:31], 0 offen offset:512 sc1
    v_exp_f32 v88, v88
    v_exp_f32 v89, v89
    v_exp_f32 v90, v90
    v_exp_f32 v91, v91
    v_cvt_pk_bf16_f32 v120, v88, v89
    v_exp_f32 v92, v92
    v_exp_f32 v93, v93
    v_cvt_pk_bf16_f32 v121, v90, v91
    v_mfma_f32_32x32x16_bf16 v[176:191], v[48:51], v[128:131], v[176:191]
    v_exp_f32 v94, v94
    v_exp_f32 v95, v95
    v_cvt_pk_bf16_f32 v122, v92, v93
    v_exp_f32 v96, v96
    v_exp_f32 v97, v97
    v_cvt_pk_bf16_f32 v123, v94, v95
    v_exp_f32 v98, v98
    v_mfma_f32_32x32x16_bf16 v[176:191], v[52:55], v[132:135], v[176:191]
    s_waitcnt vmcnt(6)
    v_exp_f32 v99, v99
    v_cvt_pk_bf16_f32 v124, v96, v97
    v_exp_f32 v100, v100
    v_exp_f32 v101, v101
    v_cvt_pk_bf16_f32 v125, v98, v99
    v_exp_f32 v102, v102
    v_exp_f32 v103, v103
    v_cvt_pk_bf16_f32 v126, v100, v101
    v_cvt_pk_bf16_f32 v127, v102, v103
    v_mfma_f32_32x32x16_bf16 v[88:103], v[32:35], v[72:75], 0
    v_exp_f32 v104, v104
    v_exp_f32 v105, v105
    v_exp_f32 v106, v106
    v_exp_f32 v107, v107
    v_cvt_pk_bf16_f32 v128, v104, v105
    v_exp_f32 v108, v108
    v_exp_f32 v109, v109
    v_cvt_pk_bf16_f32 v129, v106, v107
    v_mfma_f32_32x32x16_bf16 v[192:207], v[48:51], v[120:123], v[192:207]
    v_exp_f32 v110, v110
    v_exp_f32 v111, v111
    v_cvt_pk_bf16_f32 v130, v108, v109
    v_exp_f32 v112, v112
    v_exp_f32 v113, v113
    v_cvt_pk_bf16_f32 v131, v110, v111
    v_exp_f32 v114, v114
    v_mfma_f32_32x32x16_bf16 v[192:207], v[52:55], v[124:127], v[192:207]
    v_exp_f32 v115, v115
    v_cvt_pk_bf16_f32 v132, v112, v113
    v_exp_f32 v116, v116
    v_exp_f32 v117, v117
    v_cvt_pk_bf16_f32 v133, v114, v115
    v_exp_f32 v118, v118
    v_exp_f32 v119, v119
    v_cvt_pk_bf16_f32 v134, v116, v117
    v_cvt_pk_bf16_f32 v135, v118, v119
    v_mfma_f32_32x32x16_bf16 v[104:119], v[32:35], v[76:79], 0
    v_exp_f32 v88, v88
    v_exp_f32 v89, v89
    v_exp_f32 v90, v90
    v_exp_f32 v91, v91
    v_cvt_pk_bf16_f32 v120, v88, v89
    v_exp_f32 v92, v92
    v_exp_f32 v93, v93
    v_cvt_pk_bf16_f32 v121, v90, v91
    v_mfma_f32_32x32x16_bf16 v[208:223], v[48:51], v[128:131], v[208:223]
    s_add_u32 s52, s52, 2048
    v_exp_f32 v94, v94
    v_exp_f32 v95, v95
    v_cvt_pk_bf16_f32 v122, v92, v93
    v_exp_f32 v96, v96
    v_exp_f32 v97, v97
    v_cvt_pk_bf16_f32 v123, v94, v95
    v_exp_f32 v98, v98
    v_mfma_f32_32x32x16_bf16 v[208:223], v[52:55], v[132:135], v[208:223]
    s_cmp_eq_u32 s52, s69
    s_cselect_b32 s52, s68, s52
    v_exp_f32 v99, v99
    v_cvt_pk_bf16_f32 v124, v96, v97
    v_exp_f32 v100, v100
    v_exp_f32 v101, v101
    v_cvt_pk_bf16_f32 v125, v98, v99
    v_exp_f32 v102, v102
    v_exp_f32 v103, v103
    v_cvt_pk_bf16_f32 v126, v100, v101
    v_cvt_pk_bf16_f32 v127, v102, v103
    v_mfma_f32_32x32x16_bf16 v[88:103], v[32:35], v[80:83], 0
    v_mad_u32_u24 v152, s52, v153, v156
    v_exp_f32 v104, v104
    v_exp_f32 v105, v105
    v_exp_f32 v106, v106
    v_exp_f32 v107, v107
    v_cvt_pk_bf16_f32 v128, v104, v105
    v_exp_f32 v108, v108
    v_exp_f32 v109, v109
    v_cvt_pk_bf16_f32 v129, v106, v107
    v_mfma_f32_32x32x16_bf16 v[136:151], v[56:59], v[120:123], v[136:151]
    buffer_load_dwordx4 v[28:31], v157, s[28:31], s52 offen sc1
    v_exp_f32 v110, v110
    v_exp_f32 v111, v111
    v_cvt_pk_bf16_f32 v130, v108, v109
    v_exp_f32 v112, v112
    v_exp_f32 v113, v113
    v_cvt_pk_bf16_f32 v131, v110, v111
    v_exp_f32 v114, v114
    v_mfma_f32_32x32x16_bf16 v[136:151], v[60:63], v[124:127], v[136:151]
    buffer_load_dwordx4 v[48:51], v152, s[28:31], 0 offen offset:0 sc1
    v_exp_f32 v115, v115
    v_cvt_pk_bf16_f32 v132, v112, v113
    v_exp_f32 v116, v116
    v_exp_f32 v117, v117
    v_cvt_pk_bf16_f32 v133, v114, v115
    v_exp_f32 v118, v118
    v_exp_f32 v119, v119
    v_cvt_pk_bf16_f32 v134, v116, v117
    v_cvt_pk_bf16_f32 v135, v118, v119
    v_mfma_f32_32x32x16_bf16 v[104:119], v[32:35], v[84:87], 0
    buffer_load_dwordx4 v[52:55], v152, s[28:31], 0 offen offset:512 sc1
    v_exp_f32 v88, v88
    v_exp_f32 v89, v89
    v_exp_f32 v90, v90
    v_exp_f32 v91, v91
    v_cvt_pk_bf16_f32 v120, v88, v89
    v_exp_f32 v92, v92
    v_exp_f32 v93, v93
    v_cvt_pk_bf16_f32 v121, v90, v91
    v_mfma_f32_32x32x16_bf16 v[176:191], v[56:59], v[128:131], v[176:191]
    v_exp_f32 v94, v94
    v_exp_f32 v95, v95
    v_cvt_pk_bf16_f32 v122, v92, v93
    v_exp_f32 v96, v96
    v_exp_f32 v97, v97
    v_cvt_pk_bf16_f32 v123, v94, v95
    v_exp_f32 v98, v98
    v_mfma_f32_32x32x16_bf16 v[176:191], v[60:63], v[132:135], v[176:191]
    s_waitcnt vmcnt(6)
    v_exp_f32 v99, v99
    v_cvt_pk_bf16_f32 v124, v96, v97
    v_exp_f32 v100, v100
    v_exp_f32 v101, v101
    v_cvt_pk_bf16_f32 v125, v98, v99
    v_exp_f32 v102, v102
    v_exp_f32 v103, v103
    v_cvt_pk_bf16_f32 v126, v100, v101
    v_cvt_pk_bf16_f32 v127, v102, v103
    v_mfma_f32_32x32x16_bf16 v[88:103], v[36:39], v[72:75], 0
    v_exp_f32 v104, v104
    v_exp_f32 v105, v105
    v_exp_f32 v106, v106
    v_exp_f32 v107, v107
    v_cvt_pk_bf16_f32 v128, v104, v105
    v_exp_f32 v108, v108
    v_exp_f32 v109, v109
    v_cvt_pk_bf16_f32 v129, v106, v107
    v_mfma_f32_32x32x16_bf16 v[192:207], v[56:59], v[120:123], v[192:207]
    v_exp_f32 v110, v110
    v_exp_f32 v111, v111
    v_cvt_pk_bf16_f32 v130, v108, v109
    v_exp_f32 v112, v112
    v_exp_f32 v113, v113
    v_cvt_pk_bf16_f32 v131, v110, v111
    v_exp_f32 v114, v114
    v_mfma_f32_32x32x16_bf16 v[192:207], v[60:63], v[124:127], v[192:207]
    v_exp_f32 v115, v115
    v_cvt_pk_bf16_f32 v132, v112, v113
    v_exp_f32 v116, v116
    v_exp_f32 v117, v117
    v_cvt_pk_bf16_f32 v133, v114, v115
    v_exp_f32 v118, v118
    v_exp_f32 v119, v119
    v_cvt_pk_bf16_f32 v134, v116, v117
    v_cvt_pk_bf16_f32 v135, v118, v119
    v_mfma_f32_32x32x16_bf16 v[104:119], v[36:39], v[76:79], 0
    v_exp_f32 v88, v88
    v_exp_f32 v89, v89
    v_exp_f32 v90, v90
    v_exp_f32 v91, v91
    v_cvt_pk_bf16_f32 v120, v88, v89
    v_exp_f32 v92, v92
    v_exp_f32 v93, v93
    v_cvt_pk_bf16_f32 v121, v90, v91
    v_mfma_f32_32x32x16_bf16 v[208:223], v[56:59], v[128:131], v[208:223]
    s_add_u32 s52, s52, 2048
    v_exp_f32 v94, v94
    v_exp_f32 v95, v95
    v_cvt_pk_bf16_f32 v122, v92, v93
    v_exp_f32 v96, v96
    v_exp_f32 v97, v97
    v_cvt_pk_bf16_f32 v123, v94, v95
    v_exp_f32 v98, v98
    v_mfma_f32_32x32x16_bf16 v[208:223], v[60:63], v[132:135], v[208:223]
    s_cmp_eq_u32 s52, s69
    s_cselect_b32 s52, s68, s52
    v_exp_f32 v99, v99
    v_cvt_pk_bf16_f32 v124, v96, v97
    v_exp_f32 v100, v100
    v_exp_f32 v101, v101
    v_cvt_pk_bf16_f32 v125, v98, v99
    v_exp_f32 v102, v102
    v_exp_f32 v103, v103
    v_cvt_pk_bf16_f32 v126, v100, v101
    v_cvt_pk_bf16_f32 v127, v102, v103
    v_mfma_f32_32x32x16_bf16 v[88:103], v[36:39], v[80:83], 0
    v_mad_u32_u24 v152, s52, v153, v156
    v_exp_f32 v104, v104
    v_exp_f32 v105, v105
    v_exp_f32 v106, v106
    v_exp_f32 v107, v107
    v_cvt_pk_bf16_f32 v128, v104, v105
    v_exp_f32 v108, v108
    v_exp_f32 v109, v109
    v_cvt_pk_bf16_f32 v129, v106, v107
    v_mfma_f32_32x32x16_bf16 v[136:151], v[64:67], v[120:123], v[136:151]
    buffer_load_dwordx4 v[32:35], v157, s[28:31], s52 offen sc1
    v_exp_f32 v110, v110
    v_exp_f32 v111, v111
    v_cvt_pk_bf16_f32 v130, v108, v109
    v_exp_f32 v112, v112
    v_exp_f32 v113, v113
    v_cvt_pk_bf16_f32 v131, v110, v111
    v_exp_f32 v114, v114
    v_mfma_f32_32x32x16_bf16 v[136:151], v[68:71], v[124:127], v[136:151]
    buffer_load_dwordx4 v[56:59], v152, s[28:31], 0 offen offset:0 sc1
    v_exp_f32 v115, v115
    v_cvt_pk_bf16_f32 v132, v112, v113
    v_exp_f32 v116, v116
    v_exp_f32 v117, v117
    v_cvt_pk_bf16_f32 v133, v114, v115
    v_exp_f32 v118, v118
    v_exp_f32 v119, v119
    v_cvt_pk_bf16_f32 v134, v116, v117
    v_cvt_pk_bf16_f32 v135, v118, v119
    v_mfma_f32_32x32x16_bf16 v[104:119], v[36:39], v[84:87], 0
    buffer_load_dwordx4 v[60:63], v152, s[28:31], 0 offen offset:512 sc1
    v_exp_f32 v88, v88
    v_exp_f32 v89, v89
    v_exp_f32 v90, v90
    v_exp_f32 v91, v91
    v_cvt_pk_bf16_f32 v120, v88, v89
    v_exp_f32 v92, v92
    v_exp_f32 v93, v93
    v_cvt_pk_bf16_f32 v121, v90, v91
    v_mfma_f32_32x32x16_bf16 v[176:191], v[64:67], v[128:131], v[176:191]
    v_exp_f32 v94, v94
    v_exp_f32 v95, v95
    v_cvt_pk_bf16_f32 v122, v92, v93
    v_exp_f32 v96, v96
    v_exp_f32 v97, v97
    v_cvt_pk_bf16_f32 v123, v94, v95
    v_exp_f32 v98, v98
    v_mfma_f32_32x32x16_bf16 v[176:191], v[68:71], v[132:135], v[176:191]
    s_waitcnt vmcnt(6)
    v_exp_f32 v99, v99
    v_cvt_pk_bf16_f32 v124, v96, v97
    v_exp_f32 v100, v100
    v_exp_f32 v101, v101
    v_cvt_pk_bf16_f32 v125, v98, v99
    v_exp_f32 v102, v102
    v_exp_f32 v103, v103
    v_cvt_pk_bf16_f32 v126, v100, v101
    v_cvt_pk_bf16_f32 v127, v102, v103
    v_mfma_f32_32x32x16_bf16 v[88:103], v[24:27], v[72:75], 0
    v_exp_f32 v104, v104
    v_exp_f32 v105, v105
    v_exp_f32 v106, v106
    v_exp_f32 v107, v107
    v_cvt_pk_bf16_f32 v128, v104, v105
    v_exp_f32 v108, v108
    v_exp_f32 v109, v109
    v_cvt_pk_bf16_f32 v129, v106, v107
    v_mfma_f32_32x32x16_bf16 v[192:207], v[64:67], v[120:123], v[192:207]
    v_exp_f32 v110, v110
    v_exp_f32 v111, v111
    v_cvt_pk_bf16_f32 v130, v108, v109
    v_exp_f32 v112, v112
    v_exp_f32 v113, v113
    v_cvt_pk_bf16_f32 v131, v110, v111
    v_exp_f32 v114, v114
    v_mfma_f32_32x32x16_bf16 v[192:207], v[68:71], v[124:127], v[192:207]
    v_exp_f32 v115, v115
    v_cvt_pk_bf16_f32 v132, v112, v113
    v_exp_f32 v116, v116
    v_exp_f32 v117, v117
    v_cvt_pk_bf16_f32 v133, v114, v115
    v_exp_f32 v118, v118
    v_exp_f32 v119, v119
    v_cvt_pk_bf16_f32 v134, v116, v117
    v_cvt_pk_bf16_f32 v135, v118, v119
    s_cmp_lg_u32 s56, 0
    s_cbranch_scc1 gated_mix__softmax_full_mha__sliding_block__prompt_kernel_h2
    s_mul_i32 s45, s40, 32768
    s_add_u32 s45, s45, 0
    s_mul_i32 s46, s40, 4096
    s_add_u32 m0, s46, 114688
    s_nop 0
    buffer_load_dwordx4 v154, s[12:15], s45 offen lds
    s_add_u32 m0, s46, 115712
    s_add_u32 s45, s45, 8192
    buffer_load_dwordx4 v154, s[12:15], s45 offen lds
    s_add_u32 m0, s46, 116736
    s_add_u32 s45, s45, 8192
    buffer_load_dwordx4 v154, s[12:15], s45 offen lds
    s_add_u32 m0, s46, 117760
    s_add_u32 s45, s45, 8192
    buffer_load_dwordx4 v154, s[12:15], s45 offen lds
    s_mov_b32 s56, 1
    s_setprio 1
    s_cmp_ge_u32 s40, 4
    s_cbranch_scc1 gated_mix__softmax_full_mha__sliding_block__prompt_kernel_aloop
    s_lshl_b32 s45, s41, 4
    s_add_u32 s45, s45, s42
    s_lshl_b32 s45, s45, 2
    s_add_u32 s45, s45, s40
    s_lshl_b32 s45, s45, 7
    s_add_u32 s45, s45, 19136512
    s_mov_b64 exec, 1
    buffer_store_dwordx2 v[172:173], v174, s[28:31], s45 offen sc1
    s_mov_b64 exec, -1
    s_branch gated_mix__softmax_full_mha__sliding_block__prompt_kernel_aloop
gated_mix__softmax_full_mha__sliding_block__prompt_kernel_h2:
    s_lshr_b32 s59, s41, 1
    s_lshl_b32 s59, s59, 14
    s_add_u32 s59, s59, 19136512
    buffer_load_dwordx2 v[168:169], v175, s[28:31], s59 offen sc1
    s_add_u32 s58, s59, 8192
    buffer_load_dwordx2 v[170:171], v175, s[28:31], s58 offen sc1
    s_setprio 0
    v_mfma_f32_32x32x16_bf16 v[104:119], v[24:27], v[76:79], 0
    v_exp_f32 v88, v88
    v_exp_f32 v89, v89
    v_exp_f32 v90, v90
    v_exp_f32 v91, v91
    v_cvt_pk_bf16_f32 v120, v88, v89
    v_exp_f32 v92, v92
    v_exp_f32 v93, v93
    v_cvt_pk_bf16_f32 v121, v90, v91
    v_mfma_f32_32x32x16_bf16 v[208:223], v[64:67], v[128:131], v[208:223]
    s_add_u32 s52, s52, 2048
    v_exp_f32 v94, v94
    v_exp_f32 v95, v95
    v_cvt_pk_bf16_f32 v122, v92, v93
    v_exp_f32 v96, v96
    v_exp_f32 v97, v97
    v_cvt_pk_bf16_f32 v123, v94, v95
    v_exp_f32 v98, v98
    v_mfma_f32_32x32x16_bf16 v[208:223], v[68:71], v[132:135], v[208:223]
    s_cmp_eq_u32 s52, s69
    s_cselect_b32 s52, s68, s52
    v_exp_f32 v99, v99
    v_cvt_pk_bf16_f32 v124, v96, v97
    v_exp_f32 v100, v100
    v_exp_f32 v101, v101
    v_cvt_pk_bf16_f32 v125, v98, v99
    v_exp_f32 v102, v102
    v_exp_f32 v103, v103
    v_cvt_pk_bf16_f32 v126, v100, v101
    v_cvt_pk_bf16_f32 v127, v102, v103
    v_mfma_f32_32x32x16_bf16 v[88:103], v[24:27], v[80:83], 0
    v_mad_u32_u24 v152, s52, v153, v156
    v_exp_f32 v104, v104
    v_exp_f32 v105, v105
    v_exp_f32 v106, v106
    v_exp_f32 v107, v107
    v_cvt_pk_bf16_f32 v128, v104, v105
    v_exp_f32 v108, v108
    v_exp_f32 v109, v109
    v_cvt_pk_bf16_f32 v129, v106, v107
    v_mfma_f32_32x32x16_bf16 v[136:151], v[40:43], v[120:123], v[136:151]
    buffer_load_dwordx4 v[36:39], v157, s[28:31], s52 offen sc1
    v_exp_f32 v110, v110
    v_exp_f32 v111, v111
    v_cvt_pk_bf16_f32 v130, v108, v109
    v_exp_f32 v112, v112
    v_exp_f32 v113, v113
    v_cvt_pk_bf16_f32 v131, v110, v111
    v_exp_f32 v114, v114
    v_mfma_f32_32x32x16_bf16 v[136:151], v[44:47], v[124:127], v[136:151]
    buffer_load_dwordx4 v[64:67], v152, s[28:31], 0 offen offset:0 sc1
    v_exp_f32 v115, v115
    v_cvt_pk_bf16_f32 v132, v112, v113
    v_exp_f32 v116, v116
    v_exp_f32 v117, v117
    v_cvt_pk_bf16_f32 v133, v114, v115
    v_exp_f32 v118, v118
    v_exp_f32 v119, v119
    v_cvt_pk_bf16_f32 v134, v116, v117
    v_cvt_pk_bf16_f32 v135, v118, v119
    v_mfma_f32_32x32x16_bf16 v[104:119], v[24:27], v[84:87], 0
    buffer_load_dwordx4 v[68:71], v152, s[28:31], 0 offen offset:512 sc1
    v_exp_f32 v88, v88
    v_exp_f32 v89, v89
    v_exp_f32 v90, v90
    v_exp_f32 v91, v91
    v_cvt_pk_bf16_f32 v120, v88, v89
    v_exp_f32 v92, v92
    v_exp_f32 v93, v93
    v_cvt_pk_bf16_f32 v121, v90, v91
    v_mfma_f32_32x32x16_bf16 v[176:191], v[40:43], v[128:131], v[176:191]
    v_exp_f32 v94, v94
    v_exp_f32 v95, v95
    v_cvt_pk_bf16_f32 v122, v92, v93
    v_exp_f32 v96, v96
    v_exp_f32 v97, v97
    v_cvt_pk_bf16_f32 v123, v94, v95
    v_exp_f32 v98, v98
    v_mfma_f32_32x32x16_bf16 v[176:191], v[44:47], v[132:135], v[176:191]
    s_waitcnt vmcnt(6)
    v_exp_f32 v99, v99
    v_cvt_pk_bf16_f32 v124, v96, v97
    v_exp_f32 v100, v100
    v_exp_f32 v101, v101
    v_cvt_pk_bf16_f32 v125, v98, v99
    v_exp_f32 v102, v102
    v_exp_f32 v103, v103
    v_cvt_pk_bf16_f32 v126, v100, v101
    v_cvt_pk_bf16_f32 v127, v102, v103
    v_mfma_f32_32x32x16_bf16 v[88:103], v[28:31], v[72:75], 0
    v_exp_f32 v104, v104
    v_exp_f32 v105, v105
    v_exp_f32 v106, v106
    v_exp_f32 v107, v107
    v_cvt_pk_bf16_f32 v128, v104, v105
    v_exp_f32 v108, v108
    v_exp_f32 v109, v109
    v_cvt_pk_bf16_f32 v129, v106, v107
    v_mfma_f32_32x32x16_bf16 v[192:207], v[40:43], v[120:123], v[192:207]
    v_exp_f32 v110, v110
    v_exp_f32 v111, v111
    v_cvt_pk_bf16_f32 v130, v108, v109
    v_exp_f32 v112, v112
    v_exp_f32 v113, v113
    v_cvt_pk_bf16_f32 v131, v110, v111
    v_exp_f32 v114, v114
    v_mfma_f32_32x32x16_bf16 v[192:207], v[44:47], v[124:127], v[192:207]
    s_waitcnt vmcnt(3)
    s_mov_b32 s48, 262144
fbp_poll_31:
    v_cmp_eq_u32 s[46:47], v172, v168
    v_cmp_eq_u32 vcc, v173, v169
    s_nop 1
    s_and_b64 s[46:47], s[46:47], vcc
    v_cmp_eq_u32 vcc, v172, v170
    s_nop 1
    s_and_b64 s[46:47], s[46:47], vcc
    v_cmp_eq_u32 vcc, v173, v171
    s_nop 1
    s_and_b64 s[46:47], s[46:47], vcc
    s_cmp_eq_u64 s[46:47], exec
    s_cbranch_scc1 fbp_ok_32
    s_sub_u32 s48, s48, 1
    s_cbranch_scc1 fbp_ok_32
    s_sleep 3
fbp_poll_31_ld:
    buffer_load_dwordx2 v[168:169], v175, s[28:31], s59 offen sc1
    s_add_u32 s58, s59, 8192
    buffer_load_dwordx2 v[170:171], v175, s[28:31], s58 offen sc1
    s_waitcnt vmcnt(0)
    s_branch fbp_poll_31
fbp_ok_32:
    v_exp_f32 v115, v115
    v_cvt_pk_bf16_f32 v132, v112, v113
    v_exp_f32 v116, v116
    v_exp_f32 v117, v117
    v_cvt_pk_bf16_f32 v133, v114, v115
    v_exp_f32 v118, v118
    v_exp_f32 v119, v119
    v_cvt_pk_bf16_f32 v134, v116, v117
    v_cvt_pk_bf16_f32 v135, v118, v119
    v_mfma_f32_32x32x16_bf16 v[104:119], v[28:31], v[76:79], 0
    s_add_i32 s45, s49, 0
    v_exp_f32 v88, v88
    v_exp_f32 v89, v89
    v_exp_f32 v90, v90
    v_exp_f32 v91, v91
    v_cvt_pk_bf16_f32 v120, v88, v89
    v_exp_f32 v92, v92
    v_exp_f32 v93, v93
    v_cvt_pk_bf16_f32 v121, v90, v91
    v_mfma_f32_32x32x16_bf16 v[208:223], v[40:43], v[128:131], v[208:223]
    s_max_i32 s45, s45, 0
    s_lshl_b32 s45, s45, 11
    v_exp_f32 v94, v94
    v_exp_f32 v95, v95
    v_cvt_pk_bf16_f32 v122, v92, v93
    v_exp_f32 v96, v96
    v_exp_f32 v97, v97
    v_cvt_pk_bf16_f32 v123, v94, v95
    v_exp_f32 v98, v98
    v_mfma_f32_32x32x16_bf16 v[208:223], v[44:47], v[132:135], v[208:223]
    s_add_u32 s45, s45, s53
    s_add_u32 m0, s50, 0
    v_exp_f32 v99, v99
    v_cvt_pk_bf16_f32 v124, v96, v97
    v_exp_f32 v100, v100
    v_exp_f32 v101, v101
    v_cvt_pk_bf16_f32 v125, v98, v99
    v_exp_f32 v102, v102
    v_exp_f32 v103, v103
    v_cvt_pk_bf16_f32 v126, v100, v101
    v_cvt_pk_bf16_f32 v127, v102, v103
    v_mfma_f32_32x32x16_bf16 v[88:103], v[28:31], v[80:83], 0
    v_exp_f32 v104, v104
    v_exp_f32 v105, v105
    v_exp_f32 v106, v106
    v_exp_f32 v107, v107
    v_cvt_pk_bf16_f32 v128, v104, v105
    v_exp_f32 v108, v108
    v_exp_f32 v109, v109
    v_cvt_pk_bf16_f32 v129, v106, v107
    v_mfma_f32_32x32x16_bf16 v[136:151], v[48:51], v[120:123], v[136:151]
    buffer_load_dwordx4 v157, s[28:31], s45 offen sc1 lds
    v_exp_f32 v110, v110
    v_exp_f32 v111, v111
    v_cvt_pk_bf16_f32 v130, v108, v109
    v_exp_f32 v112, v112
    v_exp_f32 v113, v113
    v_cvt_pk_bf16_f32 v131, v110, v111
    v_exp_f32 v114, v114
    v_mfma_f32_32x32x16_bf16 v[136:151], v[52:55], v[124:127], v[136:151]
    buffer_load_dwordx4 v157, s[28:31], s45 offen offset:1024 sc1 lds
    v_exp_f32 v115, v115
    v_cvt_pk_bf16_f32 v132, v112, v113
    v_exp_f32 v116, v116
    v_exp_f32 v117, v117
    v_cvt_pk_bf16_f32 v133, v114, v115
    v_exp_f32 v118, v118
    v_exp_f32 v119, v119
    v_cvt_pk_bf16_f32 v134, v116, v117
    v_cvt_pk_bf16_f32 v135, v118, v119
    v_mfma_f32_32x32x16_bf16 v[104:119], v[28:31], v[84:87], 0
    v_exp_f32 v88, v88
    v_exp_f32 v89, v89
    v_exp_f32 v90, v90
    v_exp_f32 v91, v91
    v_cvt_pk_bf16_f32 v120, v88, v89
    v_exp_f32 v92, v92
    v_exp_f32 v93, v93
    v_cvt_pk_bf16_f32 v121, v90, v91
    v_mfma_f32_32x32x16_bf16 v[176:191], v[48:51], v[128:131], v[176:191]
    v_exp_f32 v94, v94
    v_exp_f32 v95, v95
    v_cvt_pk_bf16_f32 v122, v92, v93
    v_exp_f32 v96, v96
    v_exp_f32 v97, v97
    v_cvt_pk_bf16_f32 v123, v94, v95
    v_exp_f32 v98, v98
    v_mfma_f32_32x32x16_bf16 v[176:191], v[52:55], v[132:135], v[176:191]
    v_exp_f32 v99, v99
    v_cvt_pk_bf16_f32 v124, v96, v97
    v_exp_f32 v100, v100
    v_exp_f32 v101, v101
    v_cvt_pk_bf16_f32 v125, v98, v99
    v_exp_f32 v102, v102
    v_exp_f32 v103, v103
    v_cvt_pk_bf16_f32 v126, v100, v101
    v_cvt_pk_bf16_f32 v127, v102, v103
    v_mfma_f32_32x32x16_bf16 v[88:103], v[32:35], v[72:75], 0
    v_exp_f32 v104, v104
    v_exp_f32 v105, v105
    v_exp_f32 v106, v106
    v_exp_f32 v107, v107
    v_cvt_pk_bf16_f32 v128, v104, v105
    v_exp_f32 v108, v108
    v_exp_f32 v109, v109
    v_cvt_pk_bf16_f32 v129, v106, v107
    v_mfma_f32_32x32x16_bf16 v[192:207], v[48:51], v[120:123], v[192:207]
    v_exp_f32 v110, v110
    v_exp_f32 v111, v111
    v_cvt_pk_bf16_f32 v130, v108, v109
    v_exp_f32 v112, v112
    v_exp_f32 v113, v113
    v_cvt_pk_bf16_f32 v131, v110, v111
    v_exp_f32 v114, v114
    v_mfma_f32_32x32x16_bf16 v[192:207], v[52:55], v[124:127], v[192:207]
    v_exp_f32 v115, v115
    v_cvt_pk_bf16_f32 v132, v112, v113
    v_exp_f32 v116, v116
    v_exp_f32 v117, v117
    v_cvt_pk_bf16_f32 v133, v114, v115
    v_exp_f32 v118, v118
    v_exp_f32 v119, v119
    v_cvt_pk_bf16_f32 v134, v116, v117
    v_cvt_pk_bf16_f32 v135, v118, v119
    v_mfma_f32_32x32x16_bf16 v[104:119], v[32:35], v[76:79], 0
    s_add_i32 s45, s49, 1
    v_exp_f32 v88, v88
    v_exp_f32 v89, v89
    v_exp_f32 v90, v90
    v_exp_f32 v91, v91
    v_cvt_pk_bf16_f32 v120, v88, v89
    v_exp_f32 v92, v92
    v_exp_f32 v93, v93
    v_cvt_pk_bf16_f32 v121, v90, v91
    v_mfma_f32_32x32x16_bf16 v[208:223], v[48:51], v[128:131], v[208:223]
    s_max_i32 s45, s45, 0
    s_lshl_b32 s45, s45, 11
    v_exp_f32 v94, v94
    v_exp_f32 v95, v95
    v_cvt_pk_bf16_f32 v122, v92, v93
    v_exp_f32 v96, v96
    v_exp_f32 v97, v97
    v_cvt_pk_bf16_f32 v123, v94, v95
    v_exp_f32 v98, v98
    v_mfma_f32_32x32x16_bf16 v[208:223], v[52:55], v[132:135], v[208:223]
    s_add_u32 s45, s45, s53
    s_add_u32 m0, s50, 2048
    v_exp_f32 v99, v99
    v_cvt_pk_bf16_f32 v124, v96, v97
    v_exp_f32 v100, v100
    v_exp_f32 v101, v101
    v_cvt_pk_bf16_f32 v125, v98, v99
    v_exp_f32 v102, v102
    v_exp_f32 v103, v103
    v_cvt_pk_bf16_f32 v126, v100, v101
    v_cvt_pk_bf16_f32 v127, v102, v103
    v_mfma_f32_32x32x16_bf16 v[88:103], v[32:35], v[80:83], 0
    v_exp_f32 v104, v104
    v_exp_f32 v105, v105
    v_exp_f32 v106, v106
    v_exp_f32 v107, v107
    v_cvt_pk_bf16_f32 v128, v104, v105
    v_exp_f32 v108, v108
    v_exp_f32 v109, v109
    v_cvt_pk_bf16_f32 v129, v106, v107
    v_mfma_f32_32x32x16_bf16 v[136:151], v[56:59], v[120:123], v[136:151]
    buffer_load_dwordx4 v157, s[28:31], s45 offen sc1 lds
    v_exp_f32 v110, v110
    v_exp_f32 v111, v111
    v_cvt_pk_bf16_f32 v130, v108, v109
    v_exp_f32 v112, v112
    v_exp_f32 v113, v113
    v_cvt_pk_bf16_f32 v131, v110, v111
    v_exp_f32 v114, v114
    v_mfma_f32_32x32x16_bf16 v[136:151], v[60:63], v[124:127], v[136:151]
    buffer_load_dwordx4 v157, s[28:31], s45 offen offset:1024 sc1 lds
    v_exp_f32 v115, v115
    v_cvt_pk_bf16_f32 v132, v112, v113
    v_exp_f32 v116, v116
    v_exp_f32 v117, v117
    v_cvt_pk_bf16_f32 v133, v114, v115
    v_exp_f32 v118, v118
    v_exp_f32 v119, v119
    v_cvt_pk_bf16_f32 v134, v116, v117
    v_cvt_pk_bf16_f32 v135, v118, v119
    v_mfma_f32_32x32x16_bf16 v[104:119], v[32:35], v[84:87], 0
    v_exp_f32 v88, v88
    v_exp_f32 v89, v89
    v_exp_f32 v90, v90
    v_exp_f32 v91, v91
    v_cvt_pk_bf16_f32 v120, v88, v89
    v_exp_f32 v92, v92
    v_exp_f32 v93, v93
    v_cvt_pk_bf16_f32 v121, v90, v91
    v_mfma_f32_32x32x16_bf16 v[176:191], v[56:59], v[128:131], v[176:191]
    v_exp_f32 v94, v94
    v_exp_f32 v95, v95
    v_cvt_pk_bf16_f32 v122, v92, v93
    v_exp_f32 v96, v96
    v_exp_f32 v97, v97
    v_cvt_pk_bf16_f32 v123, v94, v95
    v_exp_f32 v98, v98
    v_mfma_f32_32x32x16_bf16 v[176:191], v[60:63], v[132:135], v[176:191]
    s_waitcnt vmcnt(4)
    v_exp_f32 v99, v99
    v_cvt_pk_bf16_f32 v124, v96, v97
    v_exp_f32 v100, v100
    v_exp_f32 v101, v101
    v_cvt_pk_bf16_f32 v125, v98, v99
    v_exp_f32 v102, v102
    v_exp_f32 v103, v103
    v_cvt_pk_bf16_f32 v126, v100, v101
    v_cvt_pk_bf16_f32 v127, v102, v103
    v_mfma_f32_32x32x16_bf16 v[88:103], v[36:39], v[72:75], 0
    v_exp_f32 v104, v104
    v_exp_f32 v105, v105
    v_exp_f32 v106, v106
    v_exp_f32 v107, v107
    v_cvt_pk_bf16_f32 v128, v104, v105
    v_exp_f32 v108, v108
    v_exp_f32 v109, v109
    v_cvt_pk_bf16_f32 v129, v106, v107
    v_mfma_f32_32x32x16_bf16 v[192:207], v[56:59], v[120:123], v[192:207]
    v_exp_f32 v110, v110
    v_exp_f32 v111, v111
    v_cvt_pk_bf16_f32 v130, v108, v109
    v_exp_f32 v112, v112
    v_exp_f32 v113, v113
    v_cvt_pk_bf16_f32 v131, v110, v111
    v_exp_f32 v114, v114
    v_mfma_f32_32x32x16_bf16 v[192:207], v[60:63], v[124:127], v[192:207]
    v_exp_f32 v115, v115
    v_cvt_pk_bf16_f32 v132, v112, v113
    v_exp_f32 v116, v116
    v_exp_f32 v117, v117
    v_cvt_pk_bf16_f32 v133, v114, v115
    v_exp_f32 v118, v118
    v_exp_f32 v119, v119
    v_cvt_pk_bf16_f32 v134, v116, v117
    v_cvt_pk_bf16_f32 v135, v118, v119
    v_mfma_f32_32x32x16_bf16 v[104:119], v[36:39], v[76:79], 0
    s_add_i32 s45, s49, 2
    v_exp_f32 v88, v88
    v_exp_f32 v89, v89
    v_exp_f32 v90, v90
    v_exp_f32 v91, v91
    v_cvt_pk_bf16_f32 v120, v88, v89
    v_exp_f32 v92, v92
    v_exp_f32 v93, v93
    v_cvt_pk_bf16_f32 v121, v90, v91
    v_mfma_f32_32x32x16_bf16 v[208:223], v[56:59], v[128:131], v[208:223]
    s_max_i32 s45, s45, 0
    s_lshl_b32 s45, s45, 11
    v_exp_f32 v94, v94
    v_exp_f32 v95, v95
    v_cvt_pk_bf16_f32 v122, v92, v93
    v_exp_f32 v96, v96
    v_exp_f32 v97, v97
    v_cvt_pk_bf16_f32 v123, v94, v95
    v_exp_f32 v98, v98
    v_mfma_f32_32x32x16_bf16 v[208:223], v[60:63], v[132:135], v[208:223]
    s_add_u32 s45, s45, s53
    s_add_u32 m0, s50, 4096
    v_exp_f32 v99, v99
    v_cvt_pk_bf16_f32 v124, v96, v97
    v_exp_f32 v100, v100
    v_exp_f32 v101, v101
    v_cvt_pk_bf16_f32 v125, v98, v99
    v_exp_f32 v102, v102
    v_exp_f32 v103, v103
    v_cvt_pk_bf16_f32 v126, v100, v101
    v_cvt_pk_bf16_f32 v127, v102, v103
    v_mfma_f32_32x32x16_bf16 v[88:103], v[36:39], v[80:83], 0
    v_exp_f32 v104, v104
    v_exp_f32 v105, v105
    v_exp_f32 v106, v106
    v_exp_f32 v107, v107
    v_cvt_pk_bf16_f32 v128, v104, v105
    v_exp_f32 v108, v108
    v_exp_f32 v109, v109
    v_cvt_pk_bf16_f32 v129, v106, v107
    v_mfma_f32_32x32x16_bf16 v[136:151], v[64:67], v[120:123], v[136:151]
    buffer_load_dwordx4 v157, s[28:31], s45 offen sc1 lds
    v_exp_f32 v110, v110
    v_exp_f32 v111, v111
    v_cvt_pk_bf16_f32 v130, v108, v109
    v_exp_f32 v112, v112
    v_exp_f32 v113, v113
    v_cvt_pk_bf16_f32 v131, v110, v111
    v_exp_f32 v114, v114
    v_mfma_f32_32x32x16_bf16 v[136:151], v[68:71], v[124:127], v[136:151]
    buffer_load_dwordx4 v157, s[28:31], s45 offen offset:1024 sc1 lds
    v_exp_f32 v115, v115
    v_cvt_pk_bf16_f32 v132, v112, v113
    v_exp_f32 v116, v116
    v_exp_f32 v117, v117
    v_cvt_pk_bf16_f32 v133, v114, v115
    v_exp_f32 v118, v118
    v_exp_f32 v119, v119
    v_cvt_pk_bf16_f32 v134, v116, v117
    v_cvt_pk_bf16_f32 v135, v118, v119
    v_mfma_f32_32x32x16_bf16 v[104:119], v[36:39], v[84:87], 0
    v_exp_f32 v88, v88
    v_exp_f32 v89, v89
    v_exp_f32 v90, v90
    v_exp_f32 v91, v91
    v_cvt_pk_bf16_f32 v120, v88, v89
    v_exp_f32 v92, v92
    v_exp_f32 v93, v93
    v_cvt_pk_bf16_f32 v121, v90, v91
    v_mfma_f32_32x32x16_bf16 v[176:191], v[64:67], v[128:131], v[176:191]
    v_exp_f32 v94, v94
    v_exp_f32 v95, v95
    v_cvt_pk_bf16_f32 v122, v92, v93
    v_exp_f32 v96, v96
    v_exp_f32 v97, v97
    v_cvt_pk_bf16_f32 v123, v94, v95
    v_exp_f32 v98, v98
    v_mfma_f32_32x32x16_bf16 v[176:191], v[68:71], v[132:135], v[176:191]
    v_exp_f32 v99, v99
    v_cvt_pk_bf16_f32 v124, v96, v97
    v_exp_f32 v100, v100
    v_exp_f32 v101, v101
    v_cvt_pk_bf16_f32 v125, v98, v99
    v_exp_f32 v102, v102
    v_exp_f32 v103, v103
    v_cvt_pk_bf16_f32 v126, v100, v101
    v_cvt_pk_bf16_f32 v127, v102, v103
    v_exp_f32 v104, v104
    v_exp_f32 v105, v105
    v_exp_f32 v106, v106
    v_exp_f32 v107, v107
    v_cvt_pk_bf16_f32 v128, v104, v105
    v_exp_f32 v108, v108
    v_exp_f32 v109, v109
    v_cvt_pk_bf16_f32 v129, v106, v107
    v_mfma_f32_32x32x16_bf16 v[192:207], v[64:67], v[120:123], v[192:207]
    v_exp_f32 v110, v110
    v_exp_f32 v111, v111
    v_cvt_pk_bf16_f32 v130, v108, v109
    v_exp_f32 v112, v112
    v_exp_f32 v113, v113
    v_cvt_pk_bf16_f32 v131, v110, v111
    v_exp_f32 v114, v114
    v_mfma_f32_32x32x16_bf16 v[192:207], v[68:71], v[124:127], v[192:207]
    v_exp_f32 v115, v115
    v_cvt_pk_bf16_f32 v132, v112, v113
    v_exp_f32 v116, v116
    v_exp_f32 v117, v117
    v_cvt_pk_bf16_f32 v133, v114, v115
    v_exp_f32 v118, v118
    v_exp_f32 v119, v119
    v_cvt_pk_bf16_f32 v134, v116, v117
    v_cvt_pk_bf16_f32 v135, v118, v119
    s_nop 0
    v_mfma_f32_32x32x16_bf16 v[208:223], v[64:67], v[128:131], v[208:223]
    v_mfma_f32_32x32x16_bf16 v[208:223], v[68:71], v[132:135], v[208:223]
    v_lshlrev_b32 v3, 2, v1
    s_add_u32 s45, s51, 1
    s_and_b32 s45, s45, 3
    s_lshl_b32 s46, s44, 2
    s_add_u32 s45, s45, s46
    s_mul_i32 s45, s45, 6912
    s_add_u32 s45, s45, 49152
    v_add_u32 v4, s45, v157
    v_add_u32 v5, s45, v3
    ds_write_b128 v4, v[176:179]
    ds_write_b128 v4, v[180:183] offset:1024
    ds_write_b32 v5, v184 offset:2048
    s_add_u32 s45, s51, 2
    s_and_b32 s45, s45, 3
    s_lshl_b32 s46, s44, 2
    s_add_u32 s45, s45, s46
    s_mul_i32 s45, s45, 6912
    s_add_u32 s45, s45, 51456
    v_add_u32 v4, s45, v157
    v_add_u32 v5, s45, v3
    ds_write_b128 v4, v[192:195]
    ds_write_b128 v4, v[196:199] offset:1024
    ds_write_b32 v5, v200 offset:2048
    s_add_u32 s45, s51, 3
    s_and_b32 s45, s45, 3
    s_lshl_b32 s46, s44, 2
    s_add_u32 s45, s45, s46
    s_mul_i32 s45, s45, 6912
    s_add_u32 s45, s45, 53760
    v_add_u32 v4, s45, v157
    v_add_u32 v5, s45, v3
    s_nop 3
    ds_write_b128 v4, v[208:211]
    ds_write_b128 v4, v[212:215] offset:1024
    ds_write_b32 v5, v216 offset:2048
    s_cmp_ge_u32 s40, 4
    s_cbranch_scc1 gated_mix__softmax_full_mha__sliding_block__prompt_kernel_nomask
    v_and_b32 v2, 31, v1
    v_lshrrev_b32 v7, 5, v1
    s_mul_i32 s45, s44, 12
    s_add_u32 s45, s45, s51
    s_lshl_b32 s45, s45, 11
    v_add_u32 v158, s45, v157
    v_and_b32 v4, 15, v1
    v_lshlrev_b32 v4, 4, v4
    v_lshl_add_u32 v5, v7, 8, v4
    s_add_u32 s45, s45, 17408
    v_add_u32 v5, s45, v5
    v_add_u32 v4, 147456, v4
    v_mul_u32_u24 v5, v5, v153
    v_xor_b32 v6, 1, v153
    v_mul_u32_u24 v4, v4, v6
    v_add_u32 v159, v4, v5
    v_lshlrev_b32 v160, 11, v153
    v_lshlrev_b32 v6, 2, v7
    v_sub_u32 v6, v2, v6
    s_mov_b32 s45, 0xf149f2ca
    v_subrev_u32 v7, 0, v6
    v_ashrrev_i32 v7, 31, v7
    v_and_b32 v240, s45, v7
    v_xor_b32 v224, s45, v240
    v_subrev_u32 v7, 1, v6
    v_ashrrev_i32 v7, 31, v7
    v_and_b32 v241, s45, v7
    v_xor_b32 v225, s45, v241
    v_subrev_u32 v7, 2, v6
    v_ashrrev_i32 v7, 31, v7
    v_and_b32 v242, s45, v7
    v_xor_b32 v226, s45, v242
    v_subrev_u32 v7, 3, v6
    v_ashrrev_i32 v7, 31, v7
    v_and_b32 v243, s45, v7
    v_xor_b32 v227, s45, v243
    v_subrev_u32 v7, 8, v6
    v_ashrrev_i32 v7, 31, v7
    v_and_b32 v244, s45, v7
    v_xor_b32 v228, s45, v244
    v_subrev_u32 v7, 9, v6
    v_ashrrev_i32 v7, 31, v7
    v_and_b32 v245, s45, v7
    v_xor_b32 v229, s45, v245
    v_subrev_u32 v7, 10, v6
    v_ashrrev_i32 v7, 31, v7
    v_and_b32 v246, s45, v7
    v_xor_b32 v230, s45, v246
    v_subrev_u32 v7, 11, v6
    v_ashrrev_i32 v7, 31, v7
    v_and_b32 v247, s45, v7
    v_xor_b32 v231, s45, v247
    v_subrev_u32 v7, 16, v6
    v_ashrrev_i32 v7, 31, v7
    v_and_b32 v248, s45, v7
    v_xor_b32 v232, s45, v248
    v_subrev_u32 v7, 17, v6
    v_ashrrev_i32 v7, 31, v7
    v_and_b32 v249, s45, v7
    v_xor_b32 v233, s45, v249
    v_subrev_u32 v7, 18, v6
    v_ashrrev_i32 v7, 31, v7
    v_and_b32 v250, s45, v7
    v_xor_b32 v234, s45, v250
    v_subrev_u32 v7, 19, v6
    v_ashrrev_i32 v7, 31, v7
    v_and_b32 v251, s45, v7
    v_xor_b32 v235, s45, v251
    v_subrev_u32 v7, 24, v6
    v_ashrrev_i32 v7, 31, v7
    v_and_b32 v252, s45, v7
    v_xor_b32 v236, s45, v252
    v_subrev_u32 v7, 25, v6
    v_ashrrev_i32 v7, 31, v7
    v_and_b32 v253, s45, v7
    v_xor_b32 v237, s45, v253
    v_subrev_u32 v7, 26, v6
    v_ashrrev_i32 v7, 31, v7
    v_and_b32 v254, s45, v7
    v_xor_b32 v238, s45, v254
    v_subrev_u32 v7, 27, v6
    v_ashrrev_i32 v7, 31, v7
    v_and_b32 v255, s45, v7
    v_xor_b32 v239, s45, v255
gated_mix__softmax_full_mha__sliding_block__prompt_kernel_nomask:
    s_lshl_b32 s45, s40, 10
    s_add_u32 s45, s45, 155648
    v_add_u32 v4, s45, v157
    s_waitcnt vmcnt(0) lgkmcnt(0)
    s_barrier
    s_cmp_lg_u32 s40, 0
    s_cbranch_scc1 gated_mix__softmax_full_mha__sliding_block__prompt_kernel_no1x
    v_mov_b32 v20, 0x3f803f80
    v_mov_b32 v21, 0x3f803f80
    v_mov_b32 v22, 0x3f803f80
    v_mov_b32 v23, 0x3f803f80
    v_and_b32 v12, 11, v1
    v_cmp_eq_u32 vcc, 0, v12
    s_nop 1
    v_cndmask_b32 v20, 0, v20, vcc
    v_cndmask_b32 v21, 0, v21, vcc
    v_cndmask_b32 v22, 0, v22, vcc
    v_cndmask_b32 v23, 0, v23, vcc
    v_add_u32 v12, 147456, v157
    ds_write_b128 v12, v[20:23]
gated_mix__softmax_full_mha__sliding_block__prompt_kernel_no1x:
    ds_read_b128 v[8:11], v4
    ds_read_b128 v[24:27], v158 offset:16384
    ds_read_b128 v[28:31], v158 offset:14336
    s_mul_i32 s45, s40, 6912
    s_add_u32 s45, s45, 49152
    v_add_u32 v4, s45, v157
    v_add_u32 v5, s45, v3
    ds_read_b128 v[176:179], v4 offset:0
    ds_read_b128 v[180:183], v4 offset:1024
    ds_read_b32 v184, v5 offset:2048
    ds_read_b128 v[192:195], v4 offset:2304
    ds_read_b128 v[196:199], v4 offset:3328
    ds_read_b32 v200, v5 offset:4352
    ds_read_b128 v[208:211], v4 offset:4608
    ds_read_b128 v[212:215], v4 offset:5632
    ds_read_b32 v216, v5 offset:6656
    s_waitcnt lgkmcnt(9)
    v_mfma_f32_32x32x16_bf16 v[88:103], v[24:27], v[8:11], v[240:255]
    s_waitcnt lgkmcnt(0)
    v_add_f32 v136, v136, v176
    v_add_f32 v137, v137, v177
    v_add_f32 v138, v138, v178
    v_add_f32 v139, v139, v179
    v_add_f32 v140, v140, v180
    v_add_f32 v141, v141, v181
    v_add_f32 v142, v142, v182
    v_add_f32 v143, v143, v183
    v_add_f32 v144, v144, v184
    v_add_f32 v136, v136, v192
    v_add_f32 v137, v137, v193
    v_add_f32 v138, v138, v194
    v_add_f32 v139, v139, v195
    v_add_f32 v140, v140, v196
    v_add_f32 v141, v141, v197
    v_add_f32 v142, v142, v198
    v_add_f32 v143, v143, v199
    v_add_f32 v144, v144, v200
    v_add_f32 v136, v136, v208
    v_add_f32 v137, v137, v209
    v_add_f32 v138, v138, v210
    v_add_f32 v139, v139, v211
    v_add_f32 v140, v140, v212
    v_add_f32 v141, v141, v213
    v_add_f32 v142, v142, v214
    v_add_f32 v143, v143, v215
    v_add_f32 v144, v144, v216
    v_add_f32 v218, |v136|, |v137|
    v_add_f32 v218, v218, |v138|
    v_add_f32 v218, v218, |v139|
    v_add_f32 v218, v218, |v140|
    v_add_f32 v218, v218, |v141|
    v_add_f32 v218, v218, |v142|
    v_add_f32 v218, v218, |v143|
    s_mov_b32 s45, 0x21800000
    s_mov_b32 s46, 0x5d800000
    s_mov_b32 s47, 0x7b800000
    v_cmp_le_f32 s[70:71], s45, v144
    v_cmp_ge_f32 vcc, s46, v144
    s_nop 1
    s_and_b64 s[70:71], s[70:71], vcc
    v_cmp_gt_f32 vcc, s47, v218
    s_nop 1
    s_and_b64 s[70:71], s[70:71], vcc
    s_cmp_eq_u64 s[70:71], exec
    s_cbranch_scc1 gated_mix__softmax_full_mha__sliding_block__prompt_kernel_safeA_33
    v_mov_b32 v212, v72
    v_mov_b32 v213, v73
    v_mov_b32 v214, v74
    v_mov_b32 v215, v75
    v_mov_b32 v136, 0
    v_mov_b32 v137, 0
    v_mov_b32 v138, 0
    v_mov_b32 v139, 0
    v_mov_b32 v140, 0
    v_mov_b32 v141, 0
    v_mov_b32 v142, 0
    v_mov_b32 v143, 0
    v_mov_b32 v144, 0
    v_mov_b32 v145, 0
    v_mov_b32 v146, 0
    v_mov_b32 v147, 0
    v_mov_b32 v148, 0
    v_mov_b32 v149, 0
    v_mov_b32 v150, 0
    v_mov_b32 v151, 0
    v_mov_b32 v216, 0xff7fffff
    s_mov_b32 s70, 0
    s_mov_b32 s71, 64
gated_mix__softmax_full_mha__sliding_block__prompt_kernel_slowA_34:
    s_lshl_b32 s45, s70, 11
    s_lshl_b32 s46, s43, 17
    s_add_u32 s45, s45, s46
    s_add_u32 s45, s45, 4194304
    v_mad_u32_u24 v152, s45, v153, v156
    buffer_load_dwordx4 v[192:195], v157, s[28:31], s45 offen sc1
    buffer_load_dwordx4 v[196:199], v152, s[28:31], 0 offen offset:0 sc1
    buffer_load_dwordx4 v[200:203], v152, s[28:31], 0 offen offset:512 sc1
    s_waitcnt vmcnt(0)
    v_mfma_f32_32x32x16_bf16 v[176:191], v[192:195], v[212:215], 0
    s_nop 7
    s_nop 7
    v_max_f32 v218, v176, v177
    v_max3_f32 v218, v218, v178, v179
    v_max3_f32 v218, v218, v180, v181
    v_max3_f32 v218, v218, v182, v183
    v_max3_f32 v218, v218, v184, v185
    v_max3_f32 v218, v218, v186, v187
    v_max3_f32 v218, v218, v188, v189
    v_max3_f32 v218, v218, v190, v191
    v_mov_b32 v219, v218
    s_nop 1
    v_permlane32_swap_b32 v218, v219
    s_nop 1
    v_max3_f32 v218, v218, v219, v216
    v_sub_f32 v217, v216, v218
    v_exp_f32 v217, v217
    v_mov_b32 v216, v218
    v_sub_f32 v176, v176, v216
    v_sub_f32 v177, v177, v216
    v_sub_f32 v178, v178, v216
    v_sub_f32 v179, v179, v216
    v_sub_f32 v180, v180, v216
    v_sub_f32 v181, v181, v216
    v_sub_f32 v182, v182, v216
    v_sub_f32 v183, v183, v216
    v_sub_f32 v184, v184, v216
    v_sub_f32 v185, v185, v216
    v_sub_f32 v186, v186, v216
    v_sub_f32 v187, v187, v216
    v_sub_f32 v188, v188, v216
    v_sub_f32 v189, v189, v216
    v_sub_f32 v190, v190, v216
    v_sub_f32 v191, v191, v216
    v_exp_f32 v176, v176
    v_exp_f32 v177, v177
    v_exp_f32 v178, v178
    v_exp_f32 v179, v179
    v_exp_f32 v180, v180
    v_exp_f32 v181, v181
    v_exp_f32 v182, v182
    v_exp_f32 v183, v183
    v_exp_f32 v184, v184
    v_exp_f32 v185, v185
    v_exp_f32 v186, v186
    v_exp_f32 v187, v187
    v_exp_f32 v188, v188
    v_exp_f32 v189, v189
    v_exp_f32 v190, v190
    v_exp_f32 v191, v191
    s_nop 0
    v_cvt_pk_bf16_f32 v204, v176, v177
    v_cvt_pk_bf16_f32 v205, v178, v179
    v_cvt_pk_bf16_f32 v206, v180, v181
    v_cvt_pk_bf16_f32 v207, v182, v183
    v_cvt_pk_bf16_f32 v208, v184, v185
    v_cvt_pk_bf16_f32 v209, v186, v187
    v_cvt_pk_bf16_f32 v210, v188, v189
    v_cvt_pk_bf16_f32 v211, v190, v191
    v_mul_f32 v136, v136, v217
    v_mul_f32 v137, v137, v217
    v_mul_f32 v138, v138, v217
    v_mul_f32 v139, v139, v217
    v_mul_f32 v140, v140, v217
    v_mul_f32 v141, v141, v217
    v_mul_f32 v142, v142, v217
    v_mul_f32 v143, v143, v217
    v_mul_f32 v144, v144, v217
    v_mul_f32 v145, v145, v217
    v_mul_f32 v146, v146, v217
    v_mul_f32 v147, v147, v217
    v_mul_f32 v148, v148, v217
    v_mul_f32 v149, v149, v217
    v_mul_f32 v150, v150, v217
    v_mul_f32 v151, v151, v217
    s_nop 1
    v_mfma_f32_32x32x16_bf16 v[136:151], v[196:199], v[204:207], v[136:151]
    v_mfma_f32_32x32x16_bf16 v[136:151], v[200:203], v[208:211], v[136:151]
    s_nop 7
    s_nop 7
    s_add_u32 s70, s70, 1
    s_cmp_lt_u32 s70, s71
    s_cbranch_scc1 gated_mix__softmax_full_mha__sliding_block__prompt_kernel_slowA_34
gated_mix__softmax_full_mha__sliding_block__prompt_kernel_safeA_33:
    v_rcp_f32 v162, v144
    s_nop 0
    v_mul_f32 v161, v155, v162
    v_mul_f32 v136, v136, v161
    v_mul_f32 v137, v137, v161
    v_mul_f32 v138, v138, v161
    v_mul_f32 v139, v139, v161
    v_mul_f32 v140, v140, v161
    v_mul_f32 v141, v141, v161
    v_mul_f32 v142, v142, v161
    v_mul_f32 v143, v143, v161
    v_cvt_pk_bf16_f32 v164, v136, v137
    v_cvt_pk_bf16_f32 v165, v138, v139
    v_cvt_pk_bf16_f32 v166, v140, v141
    v_cvt_pk_bf16_f32 v167, v142, v143
    s_lshl_b32 s45, s54, 5
    s_add_u32 s45, s45, s43
    s_lshl_b32 s46, s45, 7
    s_add_u32 s57, s46, 19398656
    s_lshl_b32 s45, s45, 10
    s_add_u32 s66, s45, 13631488
    buffer_store_dwordx4 v[164:167], v157, s[28:31], s66 offen sc1
    s_lshl_b32 s49, s40, 16
    s_add_u32 s52, s49, 57344
    s_sub_u32 s49, s49, 8192
    s_lshl_b32 s50, s40, 13
    s_add_u32 m0, s50, 48128
    s_lshl_b32 s70, s40, 15
    s_lshl_b32 s71, s40, 12
    s_add_u32 s71, s71, 114688
    s_mov_b32 s53, 0
    s_barrier
    s_and_b32 s45, s2, 7
    s_lshl_b32 s45, s45, 2
    s_bfe_u32 s46, s2, 0x20003
    s_add_u32 s58, s45, s46
    s_lshr_b32 s60, s2, 5
    s_lshl_b32 s59, s58, 13
    s_add_u32 s59, s59, 19398656
    s_mov_b32 s48, 0
    s_setprio 1
    s_cmp_le_u32 s55, 1
    s_cbranch_scc1 gated_mix__softmax_full_mha__sliding_block__prompt_kernel_btail_first
    v_mfma_f32_32x32x16_bf16 v[104:119], v[28:31], v[8:11], 0
    ds_read_b128 v[24:27], v158 offset:12288
    v_exp_f32 v88, v88
    v_exp_f32 v89, v89
    v_exp_f32 v90, v90
    v_exp_f32 v91, v91
    v_cvt_pk_bf16_f32 v120, v88, v89
    v_exp_f32 v92, v92
    v_exp_f32 v93, v93
    v_cvt_pk_bf16_f32 v121, v90, v91
    ds_read_b128 v[40:43], v159 offset:0
    s_add_u32 m0, m0, 1024
    s_add_u32 s49, s49, 8192
    buffer_load_dwordx4 v154, s[4:7], s49 offen lds
    v_exp_f32 v94, v94
    v_exp_f32 v95, v95
    v_cvt_pk_bf16_f32 v122, v92, v93
    v_exp_f32 v96, v96
    v_exp_f32 v97, v97
    v_cvt_pk_bf16_f32 v123, v94, v95
    v_exp_f32 v98, v98
    ds_read_b128 v[44:47], v159 offset:512
    s_add_u32 m0, m0, 1024
    s_add_u32 s49, s49, 8192
    buffer_load_dwordx4 v154, s[4:7], s49 offen lds
    v_exp_f32 v99, v99
    v_cvt_pk_bf16_f32 v124, v96, v97
    v_exp_f32 v100, v100
    v_exp_f32 v101, v101
    v_cvt_pk_bf16_f32 v125, v98, v99
    v_exp_f32 v102, v102
    v_exp_f32 v103, v103
    v_cvt_pk_bf16_f32 v126, v100, v101
    v_cvt_pk_bf16_f32 v127, v102, v103
    v_sub_u32 v159, v159, v160
    s_cmp_le_u32 s55, 2
    s_cbranch_scc1 gated_mix__softmax_full_mha__sliding_block__prompt_kernel_btail1
    s_waitcnt lgkmcnt(2)
    v_mfma_f32_32x32x16_bf16 v[88:103], v[24:27], v[8:11], 0
    ds_read_b128 v[28:31], v158 offset:10240
    v_exp_f32 v104, v104
    v_exp_f32 v105, v105
    v_exp_f32 v106, v106
    v_exp_f32 v107, v107
    v_cvt_pk_bf16_f32 v128, v104, v105
    v_exp_f32 v108, v108
    v_exp_f32 v109, v109
    v_cvt_pk_bf16_f32 v129, v106, v107
    s_waitcnt lgkmcnt(1)
    v_mfma_f32_32x32x16_bf16 v[136:151], v[40:43], v[120:123], 0
    ds_read_b128 v[48:51], v159 offset:0
    s_add_u32 m0, m0, 1024
    s_add_u32 s49, s49, 8192
    buffer_load_dwordx4 v154, s[4:7], s49 offen lds
    v_exp_f32 v110, v110
    v_exp_f32 v111, v111
    v_cvt_pk_bf16_f32 v130, v108, v109
    v_exp_f32 v112, v112
    v_exp_f32 v113, v113
    v_cvt_pk_bf16_f32 v131, v110, v111
    v_exp_f32 v114, v114
    v_mfma_f32_32x32x16_bf16 v[136:151], v[44:47], v[124:127], v[136:151]
    ds_read_b128 v[52:55], v159 offset:512
    s_add_u32 m0, m0, 1024
    s_add_u32 s49, s49, 8192
    buffer_load_dwordx4 v154, s[4:7], s49 offen lds
    v_exp_f32 v115, v115
    v_cvt_pk_bf16_f32 v132, v112, v113
    v_exp_f32 v116, v116
    v_exp_f32 v117, v117
    v_cvt_pk_bf16_f32 v133, v114, v115
    v_exp_f32 v118, v118
    v_exp_f32 v119, v119
    v_cvt_pk_bf16_f32 v134, v116, v117
    v_cvt_pk_bf16_f32 v135, v118, v119
    v_sub_u32 v159, v159, v160
    s_cmp_le_u32 s55, 3
    s_cbranch_scc1 gated_mix__softmax_full_mha__sliding_block__prompt_kernel_btail0
    s_waitcnt lgkmcnt(2)
    v_mfma_f32_32x32x16_bf16 v[104:119], v[28:31], v[8:11], 0
    ds_read_b128 v[24:27], v158 offset:8192
    v_exp_f32 v88, v88
    v_exp_f32 v89, v89
    v_exp_f32 v90, v90
    v_exp_f32 v91, v91
    v_cvt_pk_bf16_f32 v120, v88, v89
    v_exp_f32 v92, v92
    v_exp_f32 v93, v93
    v_cvt_pk_bf16_f32 v121, v90, v91
    s_waitcnt lgkmcnt(1)
    v_mfma_f32_32x32x16_bf16 v[136:151], v[48:51], v[128:131], v[136:151]
    ds_read_b128 v[40:43], v159 offset:0
    s_add_u32 m0, m0, 1024
    s_add_u32 s49, s49, 8192
    buffer_load_dwordx4 v154, s[4:7], s49 offen lds
    v_exp_f32 v94, v94
    v_exp_f32 v95, v95
    v_cvt_pk_bf16_f32 v122, v92, v93
    v_exp_f32 v96, v96
    v_exp_f32 v97, v97
    v_cvt_pk_bf16_f32 v123, v94, v95
    v_exp_f32 v98, v98
    v_mfma_f32_32x32x16_bf16 v[136:151], v[52:55], v[132:135], v[136:151]
    ds_read_b128 v[44:47], v159 offset:512
    s_add_u32 m0, m0, 1024
    s_add_u32 s49, s49, 8192
    buffer_load_dwordx4 v154, s[4:7], s49 offen lds
    v_exp_f32 v99, v99
    v_cvt_pk_bf16_f32 v124, v96, v97
    v_exp_f32 v100, v100
    v_exp_f32 v101, v101
    v_cvt_pk_bf16_f32 v125, v98, v99
    v_exp_f32 v102, v102
    v_exp_f32 v103, v103
    v_cvt_pk_bf16_f32 v126, v100, v101
    v_cvt_pk_bf16_f32 v127, v102, v103
    v_sub_u32 v159, v159, v160
    s_cmp_le_u32 s55, 4
    s_cbranch_scc1 gated_mix__softmax_full_mha__sliding_block__prompt_kernel_btail1
    s_waitcnt lgkmcnt(2)
    v_mfma_f32_32x32x16_bf16 v[88:103], v[24:27], v[8:11], 0
    ds_read_b128 v[28:31], v158 offset:6144
    v_exp_f32 v104, v104
    v_exp_f32 v105, v105
    v_exp_f32 v106, v106
    v_exp_f32 v107, v107
    v_cvt_pk_bf16_f32 v128, v104, v105
    v_exp_f32 v108, v108
    v_exp_f32 v109, v109
    v_cvt_pk_bf16_f32 v129, v106, v107
    s_waitcnt lgkmcnt(1)
    v_mfma_f32_32x32x16_bf16 v[136:151], v[40:43], v[120:123], v[136:151]
    ds_read_b128 v[48:51], v159 offset:0
    s_add_u32 m0, m0, 1024
    s_add_u32 s49, s49, 8192
    buffer_load_dwordx4 v154, s[4:7], s49 offen lds
    v_exp_f32 v110, v110
    v_exp_f32 v111, v111
    v_cvt_pk_bf16_f32 v130, v108, v109
    v_exp_f32 v112, v112
    v_exp_f32 v113, v113
    v_cvt_pk_bf16_f32 v131, v110, v111
    v_exp_f32 v114, v114
    v_mfma_f32_32x32x16_bf16 v[136:151], v[44:47], v[124:127], v[136:151]
    ds_read_b128 v[52:55], v159 offset:512
    s_add_u32 m0, m0, 1024
    s_add_u32 s49, s49, 8192
    buffer_load_dwordx4 v154, s[4:7], s49 offen lds
    v_exp_f32 v115, v115
    v_cvt_pk_bf16_f32 v132, v112, v113
    v_exp_f32 v116, v116
    v_exp_f32 v117, v117
    v_cvt_pk_bf16_f32 v133, v114, v115
    v_exp_f32 v118, v118
    v_exp_f32 v119, v119
    v_cvt_pk_bf16_f32 v134, v116, v117
    v_cvt_pk_bf16_f32 v135, v118, v119
    v_sub_u32 v159, v159, v160
    s_waitcnt vmcnt(8)
    s_mov_b64 exec, 1
    buffer_store_dwordx2 v[172:173], v174, s[28:31], s57 offen sc1
    s_mov_b64 exec, -1
    s_setprio 0
    s_cmp_le_u32 s55, 5
    s_cbranch_scc1 gated_mix__softmax_full_mha__sliding_block__prompt_kernel_btail0
    s_waitcnt lgkmcnt(2)
    v_mfma_f32_32x32x16_bf16 v[104:119], v[28:31], v[8:11], 0
    ds_read_b128 v[24:27], v158 offset:4096
    v_exp_f32 v88, v88
    v_exp_f32 v89, v89
    v_exp_f32 v90, v90
    v_exp_f32 v91, v91
    v_cvt_pk_bf16_f32 v120, v88, v89
    v_exp_f32 v92, v92
    v_exp_f32 v93, v93
    v_cvt_pk_bf16_f32 v121, v90, v91
    s_waitcnt lgkmcnt(1)
    v_mfma_f32_32x32x16_bf16 v[136:151], v[48:51], v[128:131], v[136:151]
    ds_read_b128 v[40:43], v159 offset:0
    v_exp_f32 v94, v94
    v_exp_f32 v95, v95
    v_cvt_pk_bf16_f32 v122, v92, v93
    v_exp_f32 v96, v96
    v_exp_f32 v97, v97
    v_cvt_pk_bf16_f32 v123, v94, v95
    v_exp_f32 v98, v98
    v_mfma_f32_32x32x16_bf16 v[136:151], v[52:55], v[132:135], v[136:151]
    ds_read_b128 v[44:47], v159 offset:512
    v_exp_f32 v99, v99
    v_cvt_pk_bf16_f32 v124, v96, v97
    v_exp_f32 v100, v100
    v_exp_f32 v101, v101
    v_cvt_pk_bf16_f32 v125, v98, v99
    v_exp_f32 v102, v102
    v_exp_f32 v103, v103
    v_cvt_pk_bf16_f32 v126, v100, v101
    v_cvt_pk_bf16_f32 v127, v102, v103
    v_sub_u32 v159, v159, v160
    s_cmp_le_u32 s55, 6
    s_cbranch_scc1 gated_mix__softmax_full_mha__sliding_block__prompt_kernel_btail1
    s_waitcnt lgkmcnt(2)
    v_mfma_f32_32x32x16_bf16 v[88:103], v[24:27], v[8:11], 0
    ds_read_b128 v[28:31], v158 offset:2048
    v_exp_f32 v104, v104
    v_exp_f32 v105, v105
    v_exp_f32 v106, v106
    v_exp_f32 v107, v107
    v_cvt_pk_bf16_f32 v128, v104, v105
    v_exp_f32 v108, v108
    v_exp_f32 v109, v109
    v_cvt_pk_bf16_f32 v129, v106, v107
    s_waitcnt lgkmcnt(1)
    v_mfma_f32_32x32x16_bf16 v[136:151], v[40:43], v[120:123], v[136:151]
    ds_read_b128 v[48:51], v159 offset:0
    v_exp_f32 v110, v110
    v_exp_f32 v111, v111
    v_cvt_pk_bf16_f32 v130, v108, v109
    v_exp_f32 v112, v112
    v_exp_f32 v113, v113
    v_cvt_pk_bf16_f32 v131, v110, v111
    v_exp_f32 v114, v114
    v_mfma_f32_32x32x16_bf16 v[136:151], v[44:47], v[124:127], v[136:151]
    ds_read_b128 v[52:55], v159 offset:512
    v_exp_f32 v115, v115
    v_cvt_pk_bf16_f32 v132, v112, v113
    v_exp_f32 v116, v116
    v_exp_f32 v117, v117
    v_cvt_pk_bf16_f32 v133, v114, v115
    v_exp_f32 v118, v118
    v_exp_f32 v119, v119
    v_cvt_pk_bf16_f32 v134, v116, v117
    v_cvt_pk_bf16_f32 v135, v118, v119
    v_sub_u32 v159, v159, v160
    s_cmp_le_u32 s55, 7
    s_cbranch_scc1 gated_mix__softmax_full_mha__sliding_block__prompt_kernel_btail0
    s_waitcnt lgkmcnt(2)
    v_mfma_f32_32x32x16_bf16 v[104:119], v[28:31], v[8:11], 0
    ds_read_b128 v[24:27], v158 offset:0
    v_exp_f32 v88, v88
    v_exp_f32 v89, v89
    v_exp_f32 v90, v90
    v_exp_f32 v91, v91
    v_cvt_pk_bf16_f32 v120, v88, v89
    v_exp_f32 v92, v92
    v_exp_f32 v93, v93
    v_cvt_pk_bf16_f32 v121, v90, v91
    s_waitcnt lgkmcnt(1)
    v_mfma_f32_32x32x16_bf16 v[136:151], v[48:51], v[128:131], v[136:151]
    ds_read_b128 v[40:43], v159 offset:0
    v_exp_f32 v94, v94
    v_exp_f32 v95, v95
    v_cvt_pk_bf16_f32 v122, v92, v93
    v_exp_f32 v96, v96
    v_exp_f32 v97, v97
    v_cvt_pk_bf16_f32 v123, v94, v95
    v_exp_f32 v98, v98
    v_mfma_f32_32x32x16_bf16 v[136:151], v[52:55], v[132:135], v[136:151]
    ds_read_b128 v[44:47], v159 offset:512
    v_exp_f32 v99, v99
    v_cvt_pk_bf16_f32 v124, v96, v97
    v_exp_f32 v100, v100
    v_exp_f32 v101, v101
    v_cvt_pk_bf16_f32 v125, v98, v99
    v_exp_f32 v102, v102
    v_exp_f32 v103, v103
    v_cvt_pk_bf16_f32 v126, v100, v101
    v_cvt_pk_bf16_f32 v127, v102, v103
    v_sub_u32 v159, v159, v160
    s_cmp_le_u32 s55, 8
    s_cbranch_scc1 gated_mix__softmax_full_mha__sliding_block__prompt_kernel_btail1
    s_waitcnt lgkmcnt(2)
    v_mfma_f32_32x32x16_bf16 v[88:103], v[24:27], v[8:11], v[224:239]
    v_exp_f32 v104, v104
    v_exp_f32 v105, v105
    v_exp_f32 v106, v106
    v_exp_f32 v107, v107
    v_cvt_pk_bf16_f32 v128, v104, v105
    v_exp_f32 v108, v108
    v_exp_f32 v109, v109
    v_cvt_pk_bf16_f32 v129, v106, v107
    s_waitcnt lgkmcnt(0)
    v_mfma_f32_32x32x16_bf16 v[136:151], v[40:43], v[120:123], v[136:151]
    ds_read_b128 v[48:51], v159 offset:0
    v_exp_f32 v110, v110
    v_exp_f32 v111, v111
    v_cvt_pk_bf16_f32 v130, v108, v109
    v_exp_f32 v112, v112
    v_exp_f32 v113, v113
    v_cvt_pk_bf16_f32 v131, v110, v111
    v_exp_f32 v114, v114
    v_mfma_f32_32x32x16_bf16 v[136:151], v[44:47], v[124:127], v[136:151]
    ds_read_b128 v[52:55], v159 offset:512
    v_exp_f32 v115, v115
    v_cvt_pk_bf16_f32 v132, v112, v113
    v_exp_f32 v116, v116
    v_exp_f32 v117, v117
    v_cvt_pk_bf16_f32 v133, v114, v115
    v_exp_f32 v118, v118
    v_exp_f32 v119, v119
    v_cvt_pk_bf16_f32 v134, v116, v117
    v_cvt_pk_bf16_f32 v135, v118, v119
    v_sub_u32 v159, v159, v160
    s_branch gated_mix__softmax_full_mha__sliding_block__prompt_kernel_btail0
gated_mix__softmax_full_mha__sliding_block__prompt_kernel_btail_first:
    ds_read_b128 v[40:43], v159 offset:0
    ds_read_b128 v[44:47], v159 offset:512
    v_exp_f32 v88, v88
    v_exp_f32 v89, v89
    v_exp_f32 v90, v90
    v_exp_f32 v91, v91
    v_cvt_pk_bf16_f32 v120, v88, v89
    v_exp_f32 v92, v92
    v_exp_f32 v93, v93
    v_cvt_pk_bf16_f32 v121, v90, v91
    v_exp_f32 v94, v94
    v_exp_f32 v95, v95
    v_cvt_pk_bf16_f32 v122, v92, v93
    v_exp_f32 v96, v96
    v_exp_f32 v97, v97
    v_cvt_pk_bf16_f32 v123, v94, v95
    v_exp_f32 v98, v98
    v_exp_f32 v99, v99
    v_cvt_pk_bf16_f32 v124, v96, v97
    v_exp_f32 v100, v100
    v_exp_f32 v101, v101
    v_cvt_pk_bf16_f32 v125, v98, v99
    v_exp_f32 v102, v102
    v_exp_f32 v103, v103
    v_cvt_pk_bf16_f32 v126, v100, v101
    v_cvt_pk_bf16_f32 v127, v102, v103
    s_waitcnt lgkmcnt(0)
    v_mfma_f32_32x32x16_bf16 v[136:151], v[40:43], v[120:123], 0
    v_mfma_f32_32x32x16_bf16 v[136:151], v[44:47], v[124:127], v[136:151]
    s_branch gated_mix__softmax_full_mha__sliding_block__prompt_kernel_bdone
gated_mix__softmax_full_mha__sliding_block__prompt_kernel_btail0:
    s_waitcnt lgkmcnt(0)
    ds_read_b128 v[40:43], v159 offset:0
    ds_read_b128 v[44:47], v159 offset:512
    v_exp_f32 v88, v88
    v_exp_f32 v89, v89
    v_exp_f32 v90, v90
    v_exp_f32 v91, v91
    v_cvt_pk_bf16_f32 v120, v88, v89
    v_exp_f32 v92, v92
    v_exp_f32 v93, v93
    v_cvt_pk_bf16_f32 v121, v90, v91
    v_mfma_f32_32x32x16_bf16 v[136:151], v[48:51], v[128:131], v[136:151]
    v_exp_f32 v94, v94
    v_exp_f32 v95, v95
    v_cvt_pk_bf16_f32 v122, v92, v93
    v_exp_f32 v96, v96
    v_exp_f32 v97, v97
    v_cvt_pk_bf16_f32 v123, v94, v95
    v_exp_f32 v98, v98
    v_mfma_f32_32x32x16_bf16 v[136:151], v[52:55], v[132:135], v[136:151]
    v_exp_f32 v99, v99
    v_cvt_pk_bf16_f32 v124, v96, v97
    v_exp_f32 v100, v100
    v_exp_f32 v101, v101
    v_cvt_pk_bf16_f32 v125, v98, v99
    v_exp_f32 v102, v102
    v_exp_f32 v103, v103
    v_cvt_pk_bf16_f32 v126, v100, v101
    v_cvt_pk_bf16_f32 v127, v102, v103
    s_waitcnt lgkmcnt(0)
    v_mfma_f32_32x32x16_bf16 v[136:151], v[40:43], v[120:123], v[136:151]
    v_mfma_f32_32x32x16_bf16 v[136:151], v[44:47], v[124:127], v[136:151]
    s_branch gated_mix__softmax_full_mha__sliding_block__prompt_kernel_bdone
gated_mix__softmax_full_mha__sliding_block__prompt_kernel_btail1:
    s_waitcnt lgkmcnt(0)
    ds_read_b128 v[48:51], v159 offset:0
    ds_read_b128 v[52:55], v159 offset:512
    s_cmp_lg_u32 s55, 2
    s_cbranch_scc1 gated_mix__softmax_full_mha__sliding_block__prompt_kernel_z_36
    v_mov_b32 v136, 0
    v_mov_b32 v137, 0
    v_mov_b32 v138, 0
    v_mov_b32 v139, 0
    v_mov_b32 v140, 0
    v_mov_b32 v141, 0
    v_mov_b32 v142, 0
    v_mov_b32 v143, 0
    v_mov_b32 v144, 0
    v_mov_b32 v145, 0
    v_mov_b32 v146, 0
    v_mov_b32 v147, 0
    v_mov_b32 v148, 0
    v_mov_b32 v149, 0
    v_mov_b32 v150, 0
    v_mov_b32 v151, 0
    s_nop 1
gated_mix__softmax_full_mha__sliding_block__prompt_kernel_z_36:
    v_exp_f32 v104, v104
    v_exp_f32 v105, v105
    v_exp_f32 v106, v106
    v_exp_f32 v107, v107
    v_cvt_pk_bf16_f32 v128, v104, v105
    v_exp_f32 v108, v108
    v_exp_f32 v109, v109
    v_cvt_pk_bf16_f32 v129, v106, v107
    v_mfma_f32_32x32x16_bf16 v[136:151], v[40:43], v[120:123], v[136:151]
    v_exp_f32 v110, v110
    v_exp_f32 v111, v111
    v_cvt_pk_bf16_f32 v130, v108, v109
    v_exp_f32 v112, v112
    v_exp_f32 v113, v113
    v_cvt_pk_bf16_f32 v131, v110, v111
    v_exp_f32 v114, v114
    v_mfma_f32_32x32x16_bf16 v[136:151], v[44:47], v[124:127], v[136:151]
    v_exp_f32 v115, v115
    v_cvt_pk_bf16_f32 v132, v112, v113
    v_exp_f32 v116, v116
    v_exp_f32 v117, v117
    v_cvt_pk_bf16_f32 v133, v114, v115
    v_exp_f32 v118, v118
    v_exp_f32 v119, v119
    v_cvt_pk_bf16_f32 v134, v116, v117
    v_cvt_pk_bf16_f32 v135, v118, v119
    s_waitcnt lgkmcnt(0)
    v_mfma_f32_32x32x16_bf16 v[136:151], v[48:51], v[128:131], v[136:151]
    v_mfma_f32_32x32x16_bf16 v[136:151], v[52:55], v[132:135], v[136:151]
gated_mix__softmax_full_mha__sliding_block__prompt_kernel_bdone:
    s_cmp_gt_u32 s55, 4
    s_cbranch_scc1 gated_mix__softmax_full_mha__sliding_block__prompt_kernel_bdone2
    s_waitcnt vmcnt(0)
    s_mov_b64 exec, 1
    buffer_store_dwordx2 v[172:173], v174, s[28:31], s57 offen sc1
    s_mov_b64 exec, -1
gated_mix__softmax_full_mha__sliding_block__prompt_kernel_bdone2:
    s_setprio 0
gated_mix__softmax_full_mha__sliding_block__prompt_kernel_lo_37:
    s_cmp_eq_u32 s49, s52
    s_cbranch_scc1 gated_mix__softmax_full_mha__sliding_block__prompt_kernel_ld_38
    s_add_u32 m0, m0, 1024
    s_add_u32 s49, s49, 8192
    buffer_load_dwordx4 v154, s[4:7], s49 offen lds
    s_branch gated_mix__softmax_full_mha__sliding_block__prompt_kernel_lo_37
gated_mix__softmax_full_mha__sliding_block__prompt_kernel_ld_38:
    v_sub_f32 v161, 1.0, v155
    v_cvt_pk_bf16_f32 v161, v161, v161
    v_lshlrev_b32 v161, 16, v161
    s_nop 7
    s_nop 1
    v_add_f32 v218, |v136|, |v137|
    v_add_f32 v218, v218, |v138|
    v_add_f32 v218, v218, |v139|
    v_add_f32 v218, v218, |v140|
    v_add_f32 v218, v218, |v141|
    v_add_f32 v218, v218, |v142|
    v_add_f32 v218, v218, |v143|
    s_mov_b32 s45, 0x21800000
    s_mov_b32 s46, 0x5d800000
    s_mov_b32 s47, 0x7b800000
    v_cmp_le_f32 s[70:71], s45, v144
    v_cmp_ge_f32 vcc, s46, v144
    s_nop 1
    s_and_b64 s[70:71], s[70:71], vcc
    v_cmp_gt_f32 vcc, s47, v218
    s_nop 1
    s_and_b64 s[70:71], s[70:71], vcc
    s_cmp_eq_u64 s[70:71], exec
    s_cbranch_scc1 gated_mix__softmax_full_mha__sliding_block__prompt_kernel_safeB_39
    v_mov_b32 v212, v8
    v_mov_b32 v213, v9
    v_mov_b32 v214, v10
    v_mov_b32 v215, v11
    v_mov_b32 v136, 0
    v_mov_b32 v137, 0
    v_mov_b32 v138, 0
    v_mov_b32 v139, 0
    v_mov_b32 v140, 0
    v_mov_b32 v141, 0
    v_mov_b32 v142, 0
    v_mov_b32 v143, 0
    v_mov_b32 v144, 0
    v_mov_b32 v145, 0
    v_mov_b32 v146, 0
    v_mov_b32 v147, 0
    v_mov_b32 v148, 0
    v_mov_b32 v149, 0
    v_mov_b32 v150, 0
    v_mov_b32 v151, 0
    v_mov_b32 v216, 0xff7fffff
    s_mov_b32 s70, 0
    s_mov_b32 s71, s55
gated_mix__softmax_full_mha__sliding_block__prompt_kernel_slowB_40:
    s_sub_u32 s45, s54, s70
    s_lshl_b32 s45, s45, 11
    s_add_u32 s46, s43, 32
    s_lshl_b32 s46, s46, 17
    s_add_u32 s45, s45, s46
    s_add_u32 s45, s45, 4194304
    v_mad_u32_u24 v152, s45, v153, v156
    buffer_load_dwordx4 v[192:195], v157, s[28:31], s45 offen sc1
    buffer_load_dwordx4 v[196:199], v152, s[28:31], 0 offen offset:0 sc1
    buffer_load_dwordx4 v[200:203], v152, s[28:31], 0 offen offset:512 sc1
    s_waitcnt vmcnt(0)
    v_mfma_f32_32x32x16_bf16 v[176:191], v[192:195], v[212:215], 0
    s_nop 7
    s_nop 7
    s_cmp_lg_u32 s70, 0
    s_cbranch_scc1 gated_mix__softmax_full_mha__sliding_block__prompt_kernel_sm_41
    v_add_f32 v176, v176, v240
    v_add_f32 v177, v177, v241
    v_add_f32 v178, v178, v242
    v_add_f32 v179, v179, v243
    v_add_f32 v180, v180, v244
    v_add_f32 v181, v181, v245
    v_add_f32 v182, v182, v246
    v_add_f32 v183, v183, v247
    v_add_f32 v184, v184, v248
    v_add_f32 v185, v185, v249
    v_add_f32 v186, v186, v250
    v_add_f32 v187, v187, v251
    v_add_f32 v188, v188, v252
    v_add_f32 v189, v189, v253
    v_add_f32 v190, v190, v254
    v_add_f32 v191, v191, v255
gated_mix__softmax_full_mha__sliding_block__prompt_kernel_sm_41:
    s_cmp_lg_u32 s70, 8
    s_cbranch_scc1 gated_mix__softmax_full_mha__sliding_block__prompt_kernel_sm_42
    v_add_f32 v176, v176, v224
    v_add_f32 v177, v177, v225
    v_add_f32 v178, v178, v226
    v_add_f32 v179, v179, v227
    v_add_f32 v180, v180, v228
    v_add_f32 v181, v181, v229
    v_add_f32 v182, v182, v230
    v_add_f32 v183, v183, v231
    v_add_f32 v184, v184, v232
    v_add_f32 v185, v185, v233
    v_add_f32 v186, v186, v234
    v_add_f32 v187, v187, v235
    v_add_f32 v188, v188, v236
    v_add_f32 v189, v189, v237
    v_add_f32 v190, v190, v238
    v_add_f32 v191, v191, v239
gated_mix__softmax_full_mha__sliding_block__prompt_kernel_sm_42:
    v_max_f32 v218, v176, v177
    v_max3_f32 v218, v218, v178, v179
    v_max3_f32 v218, v218, v180, v181
    v_max3_f32 v218, v218, v182, v183
    v_max3_f32 v218, v218, v184, v185
    v_max3_f32 v218, v218, v186, v187
    v_max3_f32 v218, v218, v188, v189
    v_max3_f32 v218, v218, v190, v191
    v_mov_b32 v219, v218
    s_nop 1
    v_permlane32_swap_b32 v218, v219
    s_nop 1
    v_max3_f32 v218, v218, v219, v216
    v_sub_f32 v217, v216, v218
    v_exp_f32 v217, v217
    v_mov_b32 v216, v218
    v_sub_f32 v176, v176, v216
    v_sub_f32 v177, v177, v216
    v_sub_f32 v178, v178, v216
    v_sub_f32 v179, v179, v216
    v_sub_f32 v180, v180, v216
    v_sub_f32 v181, v181, v216
    v_sub_f32 v182, v182, v216
    v_sub_f32 v183, v183, v216
    v_sub_f32 v184, v184, v216
    v_sub_f32 v185, v185, v216
    v_sub_f32 v186, v186, v216
    v_sub_f32 v187, v187, v216
    v_sub_f32 v188, v188, v216
    v_sub_f32 v189, v189, v216
    v_sub_f32 v190, v190, v216
    v_sub_f32 v191, v191, v216
    v_exp_f32 v176, v176
    v_exp_f32 v177, v177
    v_exp_f32 v178, v178
    v_exp_f32 v179, v179
    v_exp_f32 v180, v180
    v_exp_f32 v181, v181
    v_exp_f32 v182, v182
    v_exp_f32 v183, v183
    v_exp_f32 v184, v184
    v_exp_f32 v185, v185
    v_exp_f32 v186, v186
    v_exp_f32 v187, v187
    v_exp_f32 v188, v188
    v_exp_f32 v189, v189
    v_exp_f32 v190, v190
    v_exp_f32 v191, v191
    s_nop 0
    v_cvt_pk_bf16_f32 v204, v176, v177
    v_cvt_pk_bf16_f32 v205, v178, v179
    v_cvt_pk_bf16_f32 v206, v180, v181
    v_cvt_pk_bf16_f32 v207, v182, v183
    v_cvt_pk_bf16_f32 v208, v184, v185
    v_cvt_pk_bf16_f32 v209, v186, v187
    v_cvt_pk_bf16_f32 v210, v188, v189
    v_cvt_pk_bf16_f32 v211, v190, v191
    v_mul_f32 v136, v136, v217
    v_mul_f32 v137, v137, v217
    v_mul_f32 v138, v138, v217
    v_mul_f32 v139, v139, v217
    v_mul_f32 v140, v140, v217
    v_mul_f32 v141, v141, v217
    v_mul_f32 v142, v142, v217
    v_mul_f32 v143, v143, v217
    v_mul_f32 v144, v144, v217
    v_mul_f32 v145, v145, v217
    v_mul_f32 v146, v146, v217
    v_mul_f32 v147, v147, v217
    v_mul_f32 v148, v148, v217
    v_mul_f32 v149, v149, v217
    v_mul_f32 v150, v150, v217
    v_mul_f32 v151, v151, v217
    s_nop 1
    v_mfma_f32_32x32x16_bf16 v[136:151], v[196:199], v[204:207], v[136:151]
    v_mfma_f32_32x32x16_bf16 v[136:151], v[200:203], v[208:211], v[136:151]
    s_nop 7
    s_nop 7
    s_add_u32 s70, s70, 1
    s_cmp_lt_u32 s70, s71
    s_cbranch_scc1 gated_mix__softmax_full_mha__sliding_block__prompt_kernel_slowB_40
gated_mix__softmax_full_mha__sliding_block__prompt_kernel_safeB_39:
    v_rcp_f32 v162, v144
    s_nop 0
    v_mul_f32 v161, v161, v162
    v_mul_f32 v136, v136, v161
    v_mul_f32 v137, v137, v161
    v_mul_f32 v138, v138, v161
    v_mul_f32 v139, v139, v161
    v_mul_f32 v140, v140, v161
    v_mul_f32 v141, v141, v161
    v_mul_f32 v142, v142, v161
    v_mul_f32 v143, v143, v161
    v_cvt_pk_bf16_f32 v164, v136, v137
    v_cvt_pk_bf16_f32 v165, v138, v139
    v_cvt_pk_bf16_f32 v166, v140, v141
    v_cvt_pk_bf16_f32 v167, v142, v143
    s_add_u32 s45, s66, 2097152
    s_add_u32 s57, s57, 262144
    buffer_store_dwordx4 v[164:167], v157, s[28:31], s45 offen sc1
    s_and_b32 s61, s40, 1
    s_lshr_b32 s63, s40, 1
    s_cmp_lg_u32 s40, 0
    s_cbranch_scc1 gated_mix__softmax_full_mha__sliding_block__prompt_kernel_t0
    buffer_load_dwordx2 v[168:169], v175, s[28:31], s59 offen sc1
gated_mix__softmax_full_mha__sliding_block__prompt_kernel_t0:
    s_lshl_b32 s45, s58, 1
    s_add_u32 s45, s45, s61
    s_lshl_b32 s45, s45, 5
    s_lshl_b32 s46, s63, 3
    s_add_u32 s45, s45, s46
    s_lshl_b32 s45, s45, 10
    s_add_u32 s66, s45, 13631488
    v_bfe_u32 v4, v1, 2, 2
    v_and_b32 v5, 3, v1
    v_bfe_u32 v6, v1, 4, 1
    v_lshlrev_b32 v6, 1, v6
    v_lshrrev_b32 v7, 1, v5
    v_add_u32 v6, v6, v7
    s_and_b32 s45, s63, 1
    s_lshl_b32 s45, s45, 1
    s_and_b32 s46, s63, 2
    s_lshl_b32 s46, s46, 1
    s_or_b32 s45, s45, s46
    v_xor_b32 v6, s45, v6
    v_bfe_u32 v7, v4, 1, 1
    v_lshlrev_b32 v7, 2, v7
    v_xor_b32 v6, v6, v7
    v_lshlrev_b32 v6, 4, v6
    v_and_b32 v5, 1, v5
    v_lshl_add_u32 v6, v5, 3, v6
    v_lshrrev_b32 v5, 5, v1
    v_lshl_add_u32 v4, v5, 2, v4
    v_lshl_add_u32 v6, v4, 7, v6
    s_lshl_b32 s45, s63, 14
    s_add_u32 s46, s45, 49152
    v_add_u32 v8, s46, v6
    v_xor_b32 v9, 64, v8
    s_cmp_lt_u32 s63, 2
    s_cselect_b32 s46, 114688, 0
    s_and_b32 s45, s45, 16384
    s_add_u32 s46, s46, s45
    v_add_u32 v10, s46, v6
    v_xor_b32 v11, 64, v10
    s_xor_b32 s45, s63, 1
    s_lshl_b32 s46, s61, 2
    s_add_u32 s45, s45, s46
    s_mul_i32 s45, s45, 6144
    s_add_u32 s45, s45, 49152
    v_add_u32 v12, s45, v157
    s_xor_b32 s45, s63, 2
    s_lshl_b32 s46, s61, 2
    s_add_u32 s45, s45, s46
    s_mul_i32 s45, s45, 6144
    s_add_u32 s45, s45, 51200
    v_add_u32 v13, s45, v157
    s_xor_b32 s45, s63, 3
    s_lshl_b32 s46, s61, 2
    s_add_u32 s45, s45, s46
    s_mul_i32 s45, s45, 6144
    s_add_u32 s45, s45, 53248
    v_add_u32 v14, s45, v157
    s_lshl_b32 s46, s61, 2
    s_add_u32 s45, s63, s46
    s_mul_i32 s45, s45, 6144
    s_add_u32 s45, s45, 49152
    v_add_u32 v15, s45, v157
    s_mov_b32 s36, s18
    s_and_b32 s37, s19, 0xffff
    s_mov_b32 s38, 2097152
    s_mov_b32 s39, 0x20000
    v_and_b32 v7, 31, v1
    s_lshl_b32 s45, s58, 6
    s_lshl_b32 s46, s61, 5
    s_add_u32 s45, s45, s46
    v_add_u32 v7, s45, v7
    v_lshlrev_b32 v7, 10, v7
    v_lshrrev_b32 v5, 5, v1
    v_lshl_add_u32 v7, v5, 4, v7
    s_lshl_b32 s45, s60, 7
    s_lshl_b32 s46, s63, 5
    s_add_u32 s62, s45, s46
    s_waitcnt vmcnt(0) lgkmcnt(0)
    s_mov_b64 exec, 1
    buffer_store_dwordx2 v[172:173], v174, s[28:31], s57 offen sc1
    s_mov_b64 exec, -1
    s_cmp_lg_u32 s40, 0
    s_cbranch_scc1 gated_mix__softmax_full_mha__sliding_block__prompt_kernel_t1
    s_mov_b32 s45, 262144
gated_mix__softmax_full_mha__sliding_block__prompt_kernel_foa_poll_43:
    v_cmp_eq_u32 s[46:47], v172, v168
    v_cmp_eq_u32 vcc, v173, v169
    s_nop 1
    s_and_b64 s[46:47], s[46:47], vcc
    s_cmp_eq_u64 s[46:47], exec
    s_cbranch_scc1 gated_mix__softmax_full_mha__sliding_block__prompt_kernel_foa_ok_44
    s_sub_u32 s45, s45, 1
    s_cbranch_scc1 gated_mix__softmax_full_mha__sliding_block__prompt_kernel_foa_ok_44
    s_sleep 1
gated_mix__softmax_full_mha__sliding_block__prompt_kernel_foa_poll_43_ld:
    buffer_load_dwordx2 v[168:169], v175, s[28:31], s59 offen sc1
    s_waitcnt vmcnt(0)
    s_branch gated_mix__softmax_full_mha__sliding_block__prompt_kernel_foa_poll_43
gated_mix__softmax_full_mha__sliding_block__prompt_kernel_foa_ok_44:
gated_mix__softmax_full_mha__sliding_block__prompt_kernel_t1:
    s_barrier
    s_add_u32 s45, s66, 0
    buffer_load_dwordx4 v[176:179], v157, s[28:31], s45 offen offset:0 sc1
    buffer_load_dwordx4 v[180:183], v157, s[28:31], s45 offen offset:1024 sc1
    buffer_load_dwordx4 v[184:187], v157, s[28:31], s45 offen offset:2048 sc1
    buffer_load_dwordx4 v[188:191], v157, s[28:31], s45 offen offset:3072 sc1
    s_add_u32 s45, s66, 4096
    buffer_load_dwordx4 v[192:195], v157, s[28:31], s45 offen offset:0 sc1
    buffer_load_dwordx4 v[196:199], v157, s[28:31], s45 offen offset:1024 sc1
    buffer_load_dwordx4 v[200:203], v157, s[28:31], s45 offen offset:2048 sc1
    buffer_load_dwordx4 v[204:207], v157, s[28:31], s45 offen offset:3072 sc1
    s_mul_i32 s45, s40, 32768
    s_add_u32 s45, s45, 262144
    s_mul_i32 s46, s40, 4096
    s_add_u32 m0, s46, 0
    s_nop 0
    buffer_load_dwordx4 v154, s[12:15], s45 offen lds
    s_add_u32 m0, s46, 1024
    s_add_u32 s45, s45, 8192
    buffer_load_dwordx4 v154, s[12:15], s45 offen lds
    s_add_u32 m0, s46, 2048
    s_add_u32 s45, s45, 8192
    buffer_load_dwordx4 v154, s[12:15], s45 offen lds
    s_add_u32 m0, s46, 3072
    s_add_u32 s45, s45, 8192
    buffer_load_dwordx4 v154, s[12:15], s45 offen lds
    ds_read_b64_tr_b16 v[16:17], v8 offset:0
    ds_read_b64_tr_b16 v[18:19], v8 offset:1024
    ds_read_b64_tr_b16 v[20:21], v9 offset:0
    ds_read_b64_tr_b16 v[22:23], v9 offset:1024
    ds_read_b64_tr_b16 v[24:25], v8 offset:2048
    ds_read_b64_tr_b16 v[26:27], v8 offset:3072
    ds_read_b64_tr_b16 v[28:29], v9 offset:2048
    ds_read_b64_tr_b16 v[30:31], v9 offset:3072
    ds_read_b64_tr_b16 v[32:33], v8 offset:4096
    ds_read_b64_tr_b16 v[34:35], v8 offset:5120
    ds_read_b64_tr_b16 v[36:37], v9 offset:4096
    ds_read_b64_tr_b16 v[38:39], v9 offset:5120
    ds_read_b64_tr_b16 v[40:41], v8 offset:6144
    ds_read_b64_tr_b16 v[42:43], v8 offset:7168
    ds_read_b64_tr_b16 v[44:45], v9 offset:6144
    ds_read_b64_tr_b16 v[46:47], v9 offset:7168
    ds_read_b64_tr_b16 v[48:49], v8 offset:8192
    ds_read_b64_tr_b16 v[50:51], v8 offset:9216
    ds_read_b64_tr_b16 v[52:53], v9 offset:8192
    ds_read_b64_tr_b16 v[54:55], v9 offset:9216
    ds_read_b64_tr_b16 v[56:57], v8 offset:10240
    ds_read_b64_tr_b16 v[58:59], v8 offset:11264
    ds_read_b64_tr_b16 v[60:61], v9 offset:10240
    ds_read_b64_tr_b16 v[62:63], v9 offset:11264
    ds_read_b64_tr_b16 v[64:65], v8 offset:12288
    ds_read_b64_tr_b16 v[66:67], v8 offset:13312
    ds_read_b64_tr_b16 v[68:69], v9 offset:12288
    ds_read_b64_tr_b16 v[70:71], v9 offset:13312
    ds_read_b64_tr_b16 v[72:73], v8 offset:14336
    ds_read_b64_tr_b16 v[74:75], v8 offset:15360
    ds_read_b64_tr_b16 v[76:77], v9 offset:14336
    ds_read_b64_tr_b16 v[78:79], v9 offset:15360
    s_waitcnt lgkmcnt(0)
    s_waitcnt vmcnt(11)
    v_mfma_f32_32x32x16_bf16 v[96:111], v[16:19], v[176:179], 0
    v_mfma_f32_32x32x16_bf16 v[112:127], v[20:23], v[176:179], 0
    s_waitcnt vmcnt(10)
    v_mfma_f32_32x32x16_bf16 v[96:111], v[24:27], v[180:183], v[96:111]
    v_mfma_f32_32x32x16_bf16 v[112:127], v[28:31], v[180:183], v[112:127]
    s_waitcnt vmcnt(9)
    v_mfma_f32_32x32x16_bf16 v[96:111], v[32:35], v[184:187], v[96:111]
    v_mfma_f32_32x32x16_bf16 v[112:127], v[36:39], v[184:187], v[112:127]
    s_waitcnt vmcnt(8)
    v_mfma_f32_32x32x16_bf16 v[96:111], v[40:43], v[188:191], v[96:111]
    v_mfma_f32_32x32x16_bf16 v[112:127], v[44:47], v[188:191], v[112:127]
    s_waitcnt vmcnt(7)
    v_mfma_f32_32x32x16_bf16 v[96:111], v[48:51], v[192:195], v[96:111]
    v_mfma_f32_32x32x16_bf16 v[112:127], v[52:55], v[192:195], v[112:127]
    s_waitcnt vmcnt(6)
    v_mfma_f32_32x32x16_bf16 v[96:111], v[56:59], v[196:199], v[96:111]
    v_mfma_f32_32x32x16_bf16 v[112:127], v[60:63], v[196:199], v[112:127]
    s_waitcnt vmcnt(5)
    v_mfma_f32_32x32x16_bf16 v[96:111], v[64:67], v[200:203], v[96:111]
    v_mfma_f32_32x32x16_bf16 v[112:127], v[68:71], v[200:203], v[112:127]
    s_waitcnt vmcnt(4)
    v_mfma_f32_32x32x16_bf16 v[96:111], v[72:75], v[204:207], v[96:111]
    v_mfma_f32_32x32x16_bf16 v[112:127], v[76:79], v[204:207], v[112:127]
    s_add_u32 s59, s59, 262144
    s_cmp_lg_u32 s40, 0
    s_cbranch_scc1 gated_mix__softmax_full_mha__sliding_block__prompt_kernel_t3
    s_mov_b32 s45, 262144
    s_branch gated_mix__softmax_full_mha__sliding_block__prompt_kernel_fob_poll_45_ld
gated_mix__softmax_full_mha__sliding_block__prompt_kernel_fob_poll_45:
    v_cmp_eq_u32 s[46:47], v172, v168
    v_cmp_eq_u32 vcc, v173, v169
    s_nop 1
    s_and_b64 s[46:47], s[46:47], vcc
    s_cmp_eq_u64 s[46:47], exec
    s_cbranch_scc1 gated_mix__softmax_full_mha__sliding_block__prompt_kernel_fob_ok_46
    s_sub_u32 s45, s45, 1
    s_cbranch_scc1 gated_mix__softmax_full_mha__sliding_block__prompt_kernel_fob_ok_46
    s_sleep 1
gated_mix__softmax_full_mha__sliding_block__prompt_kernel_fob_poll_45_ld:
    buffer_load_dwordx2 v[168:169], v175, s[28:31], s59 offen sc1
    s_waitcnt vmcnt(0)
    s_branch gated_mix__softmax_full_mha__sliding_block__prompt_kernel_fob_poll_45
gated_mix__softmax_full_mha__sliding_block__prompt_kernel_fob_ok_46:
gated_mix__softmax_full_mha__sliding_block__prompt_kernel_t3:
    s_waitcnt vmcnt(0)
    s_barrier
    s_add_u32 s45, s66, 2097152
    buffer_load_dwordx4 v[176:179], v157, s[28:31], s45 offen offset:0 sc1
    buffer_load_dwordx4 v[180:183], v157, s[28:31], s45 offen offset:1024 sc1
    buffer_load_dwordx4 v[184:187], v157, s[28:31], s45 offen offset:2048 sc1
    buffer_load_dwordx4 v[188:191], v157, s[28:31], s45 offen offset:3072 sc1
    s_add_u32 s45, s66, 2101248
    buffer_load_dwordx4 v[192:195], v157, s[28:31], s45 offen offset:0 sc1
    buffer_load_dwordx4 v[196:199], v157, s[28:31], s45 offen offset:1024 sc1
    buffer_load_dwordx4 v[200:203], v157, s[28:31], s45 offen offset:2048 sc1
    buffer_load_dwordx4 v[204:207], v157, s[28:31], s45 offen offset:3072 sc1
    ds_read_b64_tr_b16 v[16:17], v10 offset:0
    ds_read_b64_tr_b16 v[18:19], v10 offset:1024
    ds_read_b64_tr_b16 v[20:21], v11 offset:0
    ds_read_b64_tr_b16 v[22:23], v11 offset:1024
    ds_read_b64_tr_b16 v[24:25], v10 offset:2048
    ds_read_b64_tr_b16 v[26:27], v10 offset:3072
    ds_read_b64_tr_b16 v[28:29], v11 offset:2048
    ds_read_b64_tr_b16 v[30:31], v11 offset:3072
    ds_read_b64_tr_b16 v[32:33], v10 offset:4096
    ds_read_b64_tr_b16 v[34:35], v10 offset:5120
    ds_read_b64_tr_b16 v[36:37], v11 offset:4096
    ds_read_b64_tr_b16 v[38:39], v11 offset:5120
    ds_read_b64_tr_b16 v[40:41], v10 offset:6144
    ds_read_b64_tr_b16 v[42:43], v10 offset:7168
    ds_read_b64_tr_b16 v[44:45], v11 offset:6144
    ds_read_b64_tr_b16 v[46:47], v11 offset:7168
    ds_read_b64_tr_b16 v[48:49], v10 offset:8192
    ds_read_b64_tr_b16 v[50:51], v10 offset:9216
    ds_read_b64_tr_b16 v[52:53], v11 offset:8192
    ds_read_b64_tr_b16 v[54:55], v11 offset:9216
    ds_read_b64_tr_b16 v[56:57], v10 offset:10240
    ds_read_b64_tr_b16 v[58:59], v10 offset:11264
    ds_read_b64_tr_b16 v[60:61], v11 offset:10240
    ds_read_b64_tr_b16 v[62:63], v11 offset:11264
    ds_read_b64_tr_b16 v[64:65], v10 offset:12288
    ds_read_b64_tr_b16 v[66:67], v10 offset:13312
    ds_read_b64_tr_b16 v[68:69], v11 offset:12288
    ds_read_b64_tr_b16 v[70:71], v11 offset:13312
    ds_read_b64_tr_b16 v[72:73], v10 offset:14336
    ds_read_b64_tr_b16 v[74:75], v10 offset:15360
    ds_read_b64_tr_b16 v[76:77], v11 offset:14336
    ds_read_b64_tr_b16 v[78:79], v11 offset:15360
    s_waitcnt lgkmcnt(0)
    s_waitcnt vmcnt(7)
    v_mfma_f32_32x32x16_bf16 v[96:111], v[16:19], v[176:179], v[96:111]
    v_mfma_f32_32x32x16_bf16 v[112:127], v[20:23], v[176:179], v[112:127]
    s_waitcnt vmcnt(6)
    v_mfma_f32_32x32x16_bf16 v[96:111], v[24:27], v[180:183], v[96:111]
    v_mfma_f32_32x32x16_bf16 v[112:127], v[28:31], v[180:183], v[112:127]
    s_waitcnt vmcnt(5)
    v_mfma_f32_32x32x16_bf16 v[96:111], v[32:35], v[184:187], v[96:111]
    v_mfma_f32_32x32x16_bf16 v[112:127], v[36:39], v[184:187], v[112:127]
    s_waitcnt vmcnt(4)
    v_mfma_f32_32x32x16_bf16 v[96:111], v[40:43], v[188:191], v[96:111]
    v_mfma_f32_32x32x16_bf16 v[112:127], v[44:47], v[188:191], v[112:127]
    s_waitcnt vmcnt(3)
    v_mfma_f32_32x32x16_bf16 v[96:111], v[48:51], v[192:195], v[96:111]
    v_mfma_f32_32x32x16_bf16 v[112:127], v[52:55], v[192:195], v[112:127]
    s_waitcnt vmcnt(2)
    v_mfma_f32_32x32x16_bf16 v[96:111], v[56:59], v[196:199], v[96:111]
    v_mfma_f32_32x32x16_bf16 v[112:127], v[60:63], v[196:199], v[112:127]
    s_waitcnt vmcnt(1)
    v_mfma_f32_32x32x16_bf16 v[96:111], v[64:67], v[200:203], v[96:111]
    v_mfma_f32_32x32x16_bf16 v[112:127], v[68:71], v[200:203], v[112:127]
    s_waitcnt vmcnt(0)
    v_mfma_f32_32x32x16_bf16 v[96:111], v[72:75], v[204:207], v[96:111]
    v_mfma_f32_32x32x16_bf16 v[112:127], v[76:79], v[204:207], v[112:127]
    s_nop 7
    s_nop 2
    ds_write_b128 v12, v[104:107]
    ds_write_b128 v12, v[108:111] offset:1024
    ds_write_b128 v13, v[112:115]
    ds_write_b128 v13, v[116:119] offset:1024
    ds_write_b128 v14, v[120:123]
    ds_write_b128 v14, v[124:127] offset:1024
    s_waitcnt lgkmcnt(0)
    s_barrier
    ds_read_b128 v[16:19], v15 offset:0
    ds_read_b128 v[20:23], v15 offset:1024
    ds_read_b128 v[24:27], v15 offset:2048
    ds_read_b128 v[28:31], v15 offset:3072
    ds_read_b128 v[32:35], v15 offset:4096
    ds_read_b128 v[36:39], v15 offset:5120
    s_waitcnt lgkmcnt(4)
    v_add_f32 v96, v96, v16
    v_add_f32 v97, v97, v17
    v_add_f32 v98, v98, v18
    v_add_f32 v99, v99, v19
    v_add_f32 v100, v100, v20
    v_add_f32 v101, v101, v21
    v_add_f32 v102, v102, v22
    v_add_f32 v103, v103, v23
    s_waitcnt lgkmcnt(2)
    v_add_f32 v96, v96, v24
    v_add_f32 v97, v97, v25
    v_add_f32 v98, v98, v26
    v_add_f32 v99, v99, v27
    v_add_f32 v100, v100, v28
    v_add_f32 v101, v101, v29
    v_add_f32 v102, v102, v30
    v_add_f32 v103, v103, v31
    s_waitcnt lgkmcnt(0)
    v_add_f32 v96, v96, v32
    v_add_f32 v97, v97, v33
    v_add_f32 v98, v98, v34
    v_add_f32 v99, v99, v35
    v_add_f32 v100, v100, v36
    v_add_f32 v101, v101, v37
    v_add_f32 v102, v102, v38
    v_add_f32 v103, v103, v39
    v_cvt_pk_bf16_f32 v48, v96, v97
    v_cvt_pk_bf16_f32 v49, v98, v99
    v_cvt_pk_bf16_f32 v50, v100, v101
    v_cvt_pk_bf16_f32 v51, v102, v103
    s_nop 1
    v_permlane32_swap_b32 v48, v50
    v_permlane32_swap_b32 v49, v51
    buffer_store_dwordx4 v[48:51], v7, s[36:39], s62 offen
    s_or_b32 s45, s2, s40
    s_cmp_lg_u32 s45, 0
    s_cbranch_scc1 gated_mix__softmax_full_mha__sliding_block__prompt_kernel_t5
    s_mov_b32 s45, 18087936
    s_mov_b64 exec, 1
    buffer_store_dwordx2 v[172:173], v174, s[28:31], s45 offen sc1
    s_mov_b64 exec, -1
gated_mix__softmax_full_mha__sliding_block__prompt_kernel_t5:
gated_mix__softmax_full_mha__sliding_block__prompt_kernel_end:
    s_endpgm
.section .rodata,"a"
.p2align 6
.amdhsa_kernel gated_mix__softmax_full_mha__sliding_block__prompt_kernel
  .amdhsa_next_free_vgpr 256
  .amdhsa_next_free_sgpr 96
  .amdhsa_accum_offset 256
  .amdhsa_group_segment_fixed_size 0
  .amdhsa_kernarg_size 80
  .amdhsa_user_sgpr_count 2
  .amdhsa_user_sgpr_kernarg_segment_ptr 1
  .amdhsa_system_sgpr_workgroup_id_x 1
  .amdhsa_float_denorm_mode_32 3
.end_amdhsa_kernel
```
